```python
import torch

def _softmax(x, axis=-1):
    return torch.softmax(x, dim=axis)
def _gelu(x):
    return torch.nn.functional.gelu(x, approximate="tanh")
def _silu(x):
    return torch.nn.functional.silu(x)
def _sigmoid(x):
    return torch.sigmoid(x)
def _layernorm(x, axis=-1, eps=1e-5):
    m = x.mean(dim=axis, keepdim=True)
    v = x.var(dim=axis, keepdim=True, unbiased=False)
    return (x - m) / torch.sqrt(v + eps)
def _scatter_add(tgt, idx, src, axis=0):
    return tgt.clone().index_add_(axis, idx, src)
def _segment_sum(src, seg, n):
    out = torch.zeros((n,) + src.shape[1:], dtype=src.dtype)
    return out.index_add_(0, seg, src)
def _pad(x, pw):
    flat = tuple(v for pair in reversed(pw) for v in pair)
    return torch.nn.functional.pad(x, flat)

kernel_name = 'sequential_preLN__mha_block__dense_activation_mish__prompt'

def setup_inputs():

    _w = (lambda a: (lambda t: t.to(torch.bfloat16) if t.is_floating_point() else t)(torch.as_tensor(a)))
    def _A_setup():
        B, S, D, H = 1, 2048, 512, 32
        return {
            "x": _w((lambda *s: torch.randn(*s, dtype=torch.bfloat16) * 0.05)(B, S, D)),
            "wqkv": _w((lambda *s: torch.randn(*s, dtype=torch.bfloat16) * 0.05)(D, 3 * D)),
            "wo": _w((lambda *s: torch.randn(*s, dtype=torch.bfloat16) * 0.05)(D, D)),
        }
    _A_in = _A_setup()

    def _B_setup():
        B, S, D, F = 1, 2048, 512, 1376
        return {
            "x": _w((lambda *s: torch.randn(*s, dtype=torch.bfloat16) * 0.05)(B, S, D)),
            "w1": _w((lambda *s: torch.randn(*s, dtype=torch.bfloat16) * 0.8)(D, F) * (D ** -0.5)),
            "b1": _w((lambda *s: torch.randn(*s, dtype=torch.bfloat16) * 0.8)(F)),
            "w2": _w((lambda *s: torch.randn(*s, dtype=torch.bfloat16) * 0.2)(F, D) * (F ** -0.5)),
        }
    _B_in = _B_setup()

    return {
        "A_x": _A_in["x"],
        "A_wqkv": _A_in["wqkv"],
        "A_wo": _A_in["wo"],
        "B_x": _B_in["x"],
        "B_w1": _B_in["w1"],
        "B_b1": _B_in["b1"],
        "B_w2": _B_in["w2"],
    }

def reference(A_x, A_wqkv, A_wo, B_x, B_w1, B_b1, B_w2):
    def _A_ref(x, wqkv, wo):
        B, S, D = x.shape
        H = 32
        Dh = D // H
        qkv = (lambda x, *d: x.permute(*d))((x @ wqkv).reshape(B, S, 3, H, Dh), 2, 0, 3, 1, 4)
        q, k, v = qkv[0], qkv[1], qkv[2]
        scores = torch.einsum("bhqd,bhkd->bhqk", q, k) * (Dh ** -0.5)
        p = _softmax(scores, axis=-1)
        o = torch.einsum("bhqk,bhkd->bhqd", p, v)
        return (lambda x, *d: x.permute(*d))(o, 0, 2, 1, 3).reshape(B, S, D) @ wo

    def _B_ref(x, w1, b1, w2):
        h = torch.einsum("bsd,df->bsf", x, w1) + b1
        sp = torch.log1p(torch.exp(-torch.abs(h))) + torch.where(h > 0, h, torch.zeros_like(h))
        act = h * torch.tanh(sp)
        return torch.einsum("bsf,fd->bsd", act, w2)

    x = A_x
    h = x + _A_ref(_layernorm(x, axis=-1), A_wqkv, A_wo)
    h2 = h + _B_ref(_layernorm(h, axis=-1), B_w1, B_b1, B_w2)
    return h2
```

```asm
; @launch kernel=kall_kernel grid=(256,1,1) block=(1024,1,1) lds=163840
.amdgcn_target "amdgcn-amd-amdhsa--gfx950"
.text
.globl kall_kernel
.p2align 8
.type kall_kernel,@function
kall_kernel:
  s_cmp_ge_u32 s2, 256
  s_cbranch_scc1 L_kall_kernel_end
  v_lshrrev_b32 v2, 6, v0
  s_nop 0
  v_readfirstlane_b32 s20, v2
  s_nop 3
  s_cmp_ge_u32 s20, 8
  s_cbranch_scc1 L_helper
  s_load_dwordx2 s[30:31], s[0:1], 0
  s_load_dwordx2 s[32:33], s[0:1], 8
  s_load_dwordx2 s[34:35], s[0:1], 72
  s_and_b32 s3, s2, 7
  s_lshr_b32 s38, s2, 3
  s_lshr_b32 s23, s3, 1
  s_lshl_b32 s23, s23, 2
  s_and_b32 s39, s38, 3
  s_add_u32 s23, s23, s39
  s_and_b32 s24, s3, 1
  s_lshl_b32 s24, s24, 3
  s_lshr_b32 s39, s38, 2
  s_add_u32 s24, s24, s39
  v_and_b32 v1, 63, v0
  v_lshrrev_b32 v2, 6, v0
  v_lshlrev_b32 v4, 4, v1
  v_readfirstlane_b32 s20, v2
  v_and_b32 v2, 31, v1
  v_lshrrev_b32 v3, 5, v1
  s_and_b32 s21, s20, 3
  s_lshr_b32 s22, s20, 2
  v_mul_u32_u24 v5, 43691, v1
  v_lshrrev_b32 v5, 19, v5
  v_mul_u32_u24 v6, 12, v5
  v_sub_u32 v6, v1, v6
  v_lshlrev_b32 v6, 4, v6
  s_mul_i32 s39, s24, 192
  v_add_u32 v6, s39, v6
  s_lshl_b32 s38, s20, 3
  v_add_u32 v5, s38, v5
  v_mul_u32_u24 v5, 3072, v5
  v_add_u32 v14, v5, v6
  s_lshl_b32 s38, s23, 7
  s_lshl_b32 s39, s20, 4
  s_add_u32 s38, s38, s39
  v_lshrrev_b32 v5, 3, v1
  v_add_u32 v5, s38, v5
  v_lshlrev_b32 v5, 10, v5
  v_lshrrev_b32 v6, 4, v1
  v_and_b32 v7, 7, v1
  v_xor_b32 v6, v6, v7
  v_lshlrev_b32 v7, 4, v6
  v_add_u32 v10, v5, v7
  v_xor_b32 v6, 4, v6
  v_lshlrev_b32 v7, 4, v6
  v_add_u32 v11, v5, v7
  v_add_u32 v11, 8192, v11
  s_lshl_b32 s25, s20, 11
  s_mul_i32 s26, s20, 1536
  s_add_u32 s26, s26, 16384
  s_mov_b32 s46, -1
  s_mov_b32 s47, 0xffff
  s_waitcnt lgkmcnt(0)
  s_mov_b32 s4, s30
  s_mov_b32 s5, s31
  s_mov_b32 s6, 2097152
  s_mov_b32 s7, 0x00020000
  s_mov_b32 s12, s34
  s_mov_b32 s13, s35
  s_mov_b32 s14, 6291456
  s_mov_b32 s15, 0x00020000
  s_mov_b32 s8, s32
  s_mov_b32 s9, s33
  s_mov_b32 s10, 1572864
  s_mov_b32 s11, 0x00020000
  s_add_u32 m0, s25, 0
  s_movk_i32 s38, 0
  buffer_load_dwordx4 v10, s[4:7], s38 offen lds
  s_add_u32 m0, s25, 1024
  s_movk_i32 s38, 0
  buffer_load_dwordx4 v11, s[4:7], s38 offen lds
  s_add_u32 m0, s26, 0
  s_mov_b32 s38, 0
  s_mov_b64 exec, s[46:47]
  buffer_load_dwordx4 v14, s[8:11], s38 offen lds
  s_mov_b64 exec, -1
  s_add_u32 m0, s26, 768
  s_mov_b32 s38, 12288
  s_mov_b64 exec, s[46:47]
  buffer_load_dwordx4 v14, s[8:11], s38 offen lds
  s_mov_b64 exec, -1
  s_barrier
  s_add_u32 m0, s25, 28672
  s_movk_i32 s38, 128
  buffer_load_dwordx4 v10, s[4:7], s38 offen lds
  s_add_u32 m0, s25, 29696
  s_movk_i32 s38, 128
  buffer_load_dwordx4 v11, s[4:7], s38 offen lds
  s_add_u32 m0, s26, 28672
  s_mov_b32 s38, 196608
  s_mov_b64 exec, s[46:47]
  buffer_load_dwordx4 v14, s[8:11], s38 offen lds
  s_mov_b64 exec, -1
  s_add_u32 m0, s26, 29440
  s_mov_b32 s38, 208896
  s_mov_b64 exec, s[46:47]
  buffer_load_dwordx4 v14, s[8:11], s38 offen lds
  s_mov_b64 exec, -1
  s_add_u32 s27, s21, 0
  s_cmp_ge_u32 s27, 3
  s_cselect_b32 s38, 3, 0
  s_sub_u32 s27, s27, s38
  s_add_u32 s28, s21, 1
  s_cmp_ge_u32 s28, 3
  s_cselect_b32 s38, 3, 0
  s_sub_u32 s28, s28, s38
  s_add_u32 s29, s21, 2
  s_cmp_ge_u32 s29, 3
  s_cselect_b32 s38, 3, 0
  s_sub_u32 s29, s29, s38
  s_lshl_b32 s38, s21, 12
  v_lshlrev_b32 v5, 7, v2
  v_add_u32 v5, s38, v5
  v_bfe_u32 v6, v2, 1, 3
  v_xor_b32 v6, v6, v3
  v_xor_b32 v7, 0, v6
  v_lshlrev_b32 v7, 4, v7
  v_add_u32 v26, v5, v7
  v_add_u32 v30, 57344, v26
  v_xor_b32 v7, 2, v6
  v_lshlrev_b32 v7, 4, v7
  v_add_u32 v27, v5, v7
  v_add_u32 v31, 57344, v27
  v_xor_b32 v7, 4, v6
  v_lshlrev_b32 v7, 4, v7
  v_add_u32 v28, v5, v7
  v_add_u32 v32, 57344, v28
  v_xor_b32 v7, 6, v6
  v_lshlrev_b32 v7, 4, v7
  v_add_u32 v29, v5, v7
  v_add_u32 v33, 57344, v29
  v_and_b32 v5, 15, v1
  v_lshrrev_b32 v6, 2, v5
  v_lshlrev_b32 v7, 3, v3
  v_add_u32 v6, v6, v7
  v_mul_u32_u24 v6, 192, v6
  v_bfe_u32 v7, v1, 4, 1
  v_lshlrev_b32 v8, 5, v7
  v_add_u32 v6, v6, v8
  v_and_b32 v8, 3, v5
  v_lshlrev_b32 v8, 3, v8
  v_add_u32 v6, v6, v8
  s_lshl_b32 s38, s27, 6
  s_add_u32 s38, s38, 16384
  v_add_u32 v20, s38, v6
  v_add_u32 v23, 57344, v20
  s_lshl_b32 s38, s28, 6
  s_add_u32 s38, s38, 16384
  v_add_u32 v21, s38, v6
  v_add_u32 v24, 57344, v21
  s_lshl_b32 s38, s29, 6
  s_add_u32 s38, s38, 16384
  v_add_u32 v22, s38, v6
  v_add_u32 v25, 57344, v22
  v_cmp_eq_u32 vcc, v5, v7
  v_mov_b32 v9, 0x3f803f80
  v_cndmask_b32 v64, 0, v9, vcc
  v_cndmask_b32 v65, 0, v9, vcc
  v_cndmask_b32 v66, 0, v9, vcc
  v_cndmask_b32 v67, 0, v9, vcc
  v_mov_b32 v8, 0
  v_mov_b32 v9, 0
  v_mov_b32 v12, 0
  v_mov_b32 v13, 0
  v_mov_b32 v68, 0
  v_mov_b32 v69, 0
  v_mov_b32 v70, 0
  v_mov_b32 v71, 0
  v_mov_b32 v72, 0
  v_mov_b32 v73, 0
  v_mov_b32 v74, 0
  v_mov_b32 v75, 0
  v_mov_b32 v76, 0
  v_mov_b32 v77, 0
  v_mov_b32 v78, 0
  v_mov_b32 v79, 0
  v_mov_b32 v80, 0
  v_mov_b32 v81, 0
  v_mov_b32 v82, 0
  v_mov_b32 v83, 0
  v_mov_b32 v84, 0
  v_mov_b32 v85, 0
  v_mov_b32 v86, 0
  v_mov_b32 v87, 0
  v_mov_b32 v88, 0
  v_mov_b32 v89, 0
  v_mov_b32 v90, 0
  v_mov_b32 v91, 0
  v_mov_b32 v92, 0
  v_mov_b32 v93, 0
  v_mov_b32 v94, 0
  v_mov_b32 v95, 0
  v_mov_b32 v96, 0
  v_mov_b32 v97, 0
  v_mov_b32 v98, 0
  v_mov_b32 v99, 0
  v_mov_b32 v100, 0
  v_mov_b32 v101, 0
  v_mov_b32 v102, 0
  v_mov_b32 v103, 0
  s_mov_b32 s45, 0xffff0000
  s_mov_b32 s49, 0x3f803f80
  s_lshl_b32 s40, s23, 2
  s_add_u32 s40, s40, s21
  s_cmp_eq_u32 s22, 1
  s_cbranch_scc1 L_k1_qkv_kernel_roleB
  s_waitcnt vmcnt(4)
  s_barrier
  ds_read_b128 v[40:43], v26 offset:0
  ds_read_b64_tr_b16 v[48:49], v20 offset:0
  ds_read_b64_tr_b16 v[50:51], v20 offset:768
  ds_read_b64_tr_b16 v[52:53], v21 offset:0
  ds_read_b64_tr_b16 v[54:55], v21 offset:768
  ds_read_b128 v[44:47], v27 offset:0
  ds_read_b64_tr_b16 v[56:57], v20 offset:3072
  ds_read_b64_tr_b16 v[58:59], v20 offset:3840
  ds_read_b64_tr_b16 v[60:61], v21 offset:3072
  ds_read_b64_tr_b16 v[62:63], v21 offset:3840
  s_waitcnt lgkmcnt(5)
  v_mfma_f32_32x32x16_bf16 v[72:87], v[48:51], v[40:43], v[72:87]
  s_add_u32 m0, s25, 57344
  s_movk_i32 s38, 256
  buffer_load_dwordx4 v10, s[4:7], s38 offen lds
  s_add_u32 m0, s25, 58368
  s_movk_i32 s38, 256
  buffer_load_dwordx4 v11, s[4:7], s38 offen lds
  v_mfma_f32_32x32x16_bf16 v[88:103], v[52:55], v[40:43], v[88:103]
  v_mfma_f32_16x16x32_bf16 v[68:71], v[48:51], v[64:67], v[68:71]
  v_dot2c_f32_bf16 v8, s49, v40
  v_dot2c_f32_bf16 v12, v40, v40
  v_dot2c_f32_bf16 v9, s49, v41
  v_dot2c_f32_bf16 v13, v41, v41
  v_dot2c_f32_bf16 v8, s49, v42
  v_dot2c_f32_bf16 v12, v42, v42
  v_dot2c_f32_bf16 v9, s49, v43
  v_dot2c_f32_bf16 v13, v43, v43
  ds_read_b128 v[40:43], v28 offset:0
  ds_read_b64_tr_b16 v[48:49], v20 offset:6144
  ds_read_b64_tr_b16 v[50:51], v20 offset:6912
  ds_read_b64_tr_b16 v[52:53], v21 offset:6144
  ds_read_b64_tr_b16 v[54:55], v21 offset:6912
  s_waitcnt lgkmcnt(5)
  v_mfma_f32_32x32x16_bf16 v[72:87], v[56:59], v[44:47], v[72:87]
  s_add_u32 m0, s26, 57344
  s_mov_b32 s38, 393216
  s_mov_b64 exec, s[46:47]
  buffer_load_dwordx4 v14, s[8:11], s38 offen lds
  s_mov_b64 exec, -1
  v_mfma_f32_32x32x16_bf16 v[88:103], v[60:63], v[44:47], v[88:103]
  v_mfma_f32_16x16x32_bf16 v[68:71], v[56:59], v[64:67], v[68:71]
  ds_read_b128 v[44:47], v29 offset:0
  ds_read_b64_tr_b16 v[56:57], v20 offset:9216
  ds_read_b64_tr_b16 v[58:59], v20 offset:9984
  ds_read_b64_tr_b16 v[60:61], v21 offset:9216
  ds_read_b64_tr_b16 v[62:63], v21 offset:9984
  s_waitcnt lgkmcnt(5)
  v_mfma_f32_32x32x16_bf16 v[72:87], v[48:51], v[40:43], v[72:87]
  s_add_u32 m0, s26, 58112
  s_mov_b32 s38, 405504
  s_mov_b64 exec, s[46:47]
  buffer_load_dwordx4 v14, s[8:11], s38 offen lds
  s_mov_b64 exec, -1
  v_mfma_f32_32x32x16_bf16 v[88:103], v[52:55], v[40:43], v[88:103]
  v_mfma_f32_16x16x32_bf16 v[68:71], v[48:51], v[64:67], v[68:71]
  v_dot2c_f32_bf16 v8, s49, v40
  v_dot2c_f32_bf16 v12, v40, v40
  v_dot2c_f32_bf16 v9, s49, v41
  v_dot2c_f32_bf16 v13, v41, v41
  v_dot2c_f32_bf16 v8, s49, v42
  v_dot2c_f32_bf16 v12, v42, v42
  v_dot2c_f32_bf16 v9, s49, v43
  v_dot2c_f32_bf16 v13, v43, v43
  s_waitcnt vmcnt(4)
  s_barrier
  ds_read_b128 v[40:43], v26 offset:28672
  ds_read_b64_tr_b16 v[48:49], v20 offset:28672
  ds_read_b64_tr_b16 v[50:51], v20 offset:29440
  ds_read_b64_tr_b16 v[52:53], v21 offset:28672
  ds_read_b64_tr_b16 v[54:55], v21 offset:29440
  s_waitcnt lgkmcnt(5)
  v_mfma_f32_32x32x16_bf16 v[72:87], v[56:59], v[44:47], v[72:87]
  s_add_u32 m0, s25, 86016
  s_movk_i32 s38, 384
  buffer_load_dwordx4 v10, s[4:7], s38 offen lds
  v_mfma_f32_32x32x16_bf16 v[88:103], v[60:63], v[44:47], v[88:103]
  v_mfma_f32_16x16x32_bf16 v[68:71], v[56:59], v[64:67], v[68:71]
  ds_read_b128 v[44:47], v27 offset:28672
  ds_read_b64_tr_b16 v[56:57], v20 offset:31744
  ds_read_b64_tr_b16 v[58:59], v20 offset:32512
  ds_read_b64_tr_b16 v[60:61], v21 offset:31744
  ds_read_b64_tr_b16 v[62:63], v21 offset:32512
  s_waitcnt lgkmcnt(5)
  v_mfma_f32_32x32x16_bf16 v[72:87], v[48:51], v[40:43], v[72:87]
  s_add_u32 m0, s25, 87040
  s_movk_i32 s38, 384
  buffer_load_dwordx4 v11, s[4:7], s38 offen lds
  v_mfma_f32_32x32x16_bf16 v[88:103], v[52:55], v[40:43], v[88:103]
  v_mfma_f32_16x16x32_bf16 v[68:71], v[48:51], v[64:67], v[68:71]
  v_dot2c_f32_bf16 v8, s49, v40
  v_dot2c_f32_bf16 v12, v40, v40
  v_dot2c_f32_bf16 v9, s49, v41
  v_dot2c_f32_bf16 v13, v41, v41
  v_dot2c_f32_bf16 v8, s49, v42
  v_dot2c_f32_bf16 v12, v42, v42
  v_dot2c_f32_bf16 v9, s49, v43
  v_dot2c_f32_bf16 v13, v43, v43
  ds_read_b128 v[40:43], v28 offset:28672
  ds_read_b64_tr_b16 v[48:49], v20 offset:34816
  ds_read_b64_tr_b16 v[50:51], v20 offset:35584
  ds_read_b64_tr_b16 v[52:53], v21 offset:34816
  ds_read_b64_tr_b16 v[54:55], v21 offset:35584
  s_waitcnt lgkmcnt(5)
  v_mfma_f32_32x32x16_bf16 v[72:87], v[56:59], v[44:47], v[72:87]
  s_add_u32 m0, s26, 86016
  s_mov_b32 s38, 589824
  s_mov_b64 exec, s[46:47]
  buffer_load_dwordx4 v14, s[8:11], s38 offen lds
  s_mov_b64 exec, -1
  v_mfma_f32_32x32x16_bf16 v[88:103], v[60:63], v[44:47], v[88:103]
  v_mfma_f32_16x16x32_bf16 v[68:71], v[56:59], v[64:67], v[68:71]
  ds_read_b128 v[44:47], v29 offset:28672
  ds_read_b64_tr_b16 v[56:57], v20 offset:37888
  ds_read_b64_tr_b16 v[58:59], v20 offset:38656
  ds_read_b64_tr_b16 v[60:61], v21 offset:37888
  ds_read_b64_tr_b16 v[62:63], v21 offset:38656
  s_waitcnt lgkmcnt(5)
  v_mfma_f32_32x32x16_bf16 v[72:87], v[48:51], v[40:43], v[72:87]
  s_add_u32 m0, s26, 86784
  s_mov_b32 s38, 602112
  s_mov_b64 exec, s[46:47]
  buffer_load_dwordx4 v14, s[8:11], s38 offen lds
  s_mov_b64 exec, -1
  v_mfma_f32_32x32x16_bf16 v[88:103], v[52:55], v[40:43], v[88:103]
  v_mfma_f32_16x16x32_bf16 v[68:71], v[48:51], v[64:67], v[68:71]
  v_dot2c_f32_bf16 v8, s49, v40
  v_dot2c_f32_bf16 v12, v40, v40
  v_dot2c_f32_bf16 v9, s49, v41
  v_dot2c_f32_bf16 v13, v41, v41
  v_dot2c_f32_bf16 v8, s49, v42
  v_dot2c_f32_bf16 v12, v42, v42
  v_dot2c_f32_bf16 v9, s49, v43
  v_dot2c_f32_bf16 v13, v43, v43
  s_waitcnt vmcnt(4)
  s_barrier
  ds_read_b128 v[40:43], v30 offset:0
  ds_read_b64_tr_b16 v[48:49], v23 offset:0
  ds_read_b64_tr_b16 v[50:51], v23 offset:768
  ds_read_b64_tr_b16 v[52:53], v24 offset:0
  ds_read_b64_tr_b16 v[54:55], v24 offset:768
  s_waitcnt lgkmcnt(5)
  v_mfma_f32_32x32x16_bf16 v[72:87], v[56:59], v[44:47], v[72:87]
  s_add_u32 m0, s25, 0
  s_movk_i32 s38, 512
  buffer_load_dwordx4 v10, s[4:7], s38 offen lds
  v_mfma_f32_32x32x16_bf16 v[88:103], v[60:63], v[44:47], v[88:103]
  v_mfma_f32_16x16x32_bf16 v[68:71], v[56:59], v[64:67], v[68:71]
  ds_read_b128 v[44:47], v31 offset:0
  ds_read_b64_tr_b16 v[56:57], v23 offset:3072
  ds_read_b64_tr_b16 v[58:59], v23 offset:3840
  ds_read_b64_tr_b16 v[60:61], v24 offset:3072
  ds_read_b64_tr_b16 v[62:63], v24 offset:3840
  s_waitcnt lgkmcnt(5)
  v_mfma_f32_32x32x16_bf16 v[72:87], v[48:51], v[40:43], v[72:87]
  s_add_u32 m0, s25, 1024
  s_movk_i32 s38, 512
  buffer_load_dwordx4 v11, s[4:7], s38 offen lds
  v_mfma_f32_32x32x16_bf16 v[88:103], v[52:55], v[40:43], v[88:103]
  v_mfma_f32_16x16x32_bf16 v[68:71], v[48:51], v[64:67], v[68:71]
  v_dot2c_f32_bf16 v8, s49, v40
  v_dot2c_f32_bf16 v12, v40, v40
  v_dot2c_f32_bf16 v9, s49, v41
  v_dot2c_f32_bf16 v13, v41, v41
  v_dot2c_f32_bf16 v8, s49, v42
  v_dot2c_f32_bf16 v12, v42, v42
  v_dot2c_f32_bf16 v9, s49, v43
  v_dot2c_f32_bf16 v13, v43, v43
  ds_read_b128 v[40:43], v32 offset:0
  ds_read_b64_tr_b16 v[48:49], v23 offset:6144
  ds_read_b64_tr_b16 v[50:51], v23 offset:6912
  ds_read_b64_tr_b16 v[52:53], v24 offset:6144
  ds_read_b64_tr_b16 v[54:55], v24 offset:6912
  s_waitcnt lgkmcnt(5)
  v_mfma_f32_32x32x16_bf16 v[72:87], v[56:59], v[44:47], v[72:87]
  s_add_u32 m0, s26, 0
  s_mov_b32 s38, 786432
  s_mov_b64 exec, s[46:47]
  buffer_load_dwordx4 v14, s[8:11], s38 offen lds
  s_mov_b64 exec, -1
  v_mfma_f32_32x32x16_bf16 v[88:103], v[60:63], v[44:47], v[88:103]
  v_mfma_f32_16x16x32_bf16 v[68:71], v[56:59], v[64:67], v[68:71]
  ds_read_b128 v[44:47], v33 offset:0
  ds_read_b64_tr_b16 v[56:57], v23 offset:9216
  ds_read_b64_tr_b16 v[58:59], v23 offset:9984
  ds_read_b64_tr_b16 v[60:61], v24 offset:9216
  ds_read_b64_tr_b16 v[62:63], v24 offset:9984
  s_waitcnt lgkmcnt(5)
  v_mfma_f32_32x32x16_bf16 v[72:87], v[48:51], v[40:43], v[72:87]
  s_add_u32 m0, s26, 768
  s_mov_b32 s38, 798720
  s_mov_b64 exec, s[46:47]
  buffer_load_dwordx4 v14, s[8:11], s38 offen lds
  s_mov_b64 exec, -1
  v_mfma_f32_32x32x16_bf16 v[88:103], v[52:55], v[40:43], v[88:103]
  v_mfma_f32_16x16x32_bf16 v[68:71], v[48:51], v[64:67], v[68:71]
  v_dot2c_f32_bf16 v8, s49, v40
  v_dot2c_f32_bf16 v12, v40, v40
  v_dot2c_f32_bf16 v9, s49, v41
  v_dot2c_f32_bf16 v13, v41, v41
  v_dot2c_f32_bf16 v8, s49, v42
  v_dot2c_f32_bf16 v12, v42, v42
  v_dot2c_f32_bf16 v9, s49, v43
  v_dot2c_f32_bf16 v13, v43, v43
  s_waitcnt vmcnt(4)
  s_barrier
  ds_read_b128 v[40:43], v30 offset:28672
  ds_read_b64_tr_b16 v[48:49], v23 offset:28672
  ds_read_b64_tr_b16 v[50:51], v23 offset:29440
  ds_read_b64_tr_b16 v[52:53], v24 offset:28672
  ds_read_b64_tr_b16 v[54:55], v24 offset:29440
  s_waitcnt lgkmcnt(5)
  v_mfma_f32_32x32x16_bf16 v[72:87], v[56:59], v[44:47], v[72:87]
  s_add_u32 m0, s25, 28672
  s_movk_i32 s38, 640
  buffer_load_dwordx4 v10, s[4:7], s38 offen lds
  v_mfma_f32_32x32x16_bf16 v[88:103], v[60:63], v[44:47], v[88:103]
  v_mfma_f32_16x16x32_bf16 v[68:71], v[56:59], v[64:67], v[68:71]
  ds_read_b128 v[44:47], v31 offset:28672
  ds_read_b64_tr_b16 v[56:57], v23 offset:31744
  ds_read_b64_tr_b16 v[58:59], v23 offset:32512
  ds_read_b64_tr_b16 v[60:61], v24 offset:31744
  ds_read_b64_tr_b16 v[62:63], v24 offset:32512
  s_waitcnt lgkmcnt(5)
  v_mfma_f32_32x32x16_bf16 v[72:87], v[48:51], v[40:43], v[72:87]
  s_add_u32 m0, s25, 29696
  s_movk_i32 s38, 640
  buffer_load_dwordx4 v11, s[4:7], s38 offen lds
  v_mfma_f32_32x32x16_bf16 v[88:103], v[52:55], v[40:43], v[88:103]
  v_mfma_f32_16x16x32_bf16 v[68:71], v[48:51], v[64:67], v[68:71]
  v_dot2c_f32_bf16 v8, s49, v40
  v_dot2c_f32_bf16 v12, v40, v40
  v_dot2c_f32_bf16 v9, s49, v41
  v_dot2c_f32_bf16 v13, v41, v41
  v_dot2c_f32_bf16 v8, s49, v42
  v_dot2c_f32_bf16 v12, v42, v42
  v_dot2c_f32_bf16 v9, s49, v43
  v_dot2c_f32_bf16 v13, v43, v43
  ds_read_b128 v[40:43], v32 offset:28672
  ds_read_b64_tr_b16 v[48:49], v23 offset:34816
  ds_read_b64_tr_b16 v[50:51], v23 offset:35584
  ds_read_b64_tr_b16 v[52:53], v24 offset:34816
  ds_read_b64_tr_b16 v[54:55], v24 offset:35584
  s_waitcnt lgkmcnt(5)
  v_mfma_f32_32x32x16_bf16 v[72:87], v[56:59], v[44:47], v[72:87]
  s_add_u32 m0, s26, 28672
  s_mov_b32 s38, 983040
  s_mov_b64 exec, s[46:47]
  buffer_load_dwordx4 v14, s[8:11], s38 offen lds
  s_mov_b64 exec, -1
  v_mfma_f32_32x32x16_bf16 v[88:103], v[60:63], v[44:47], v[88:103]
  v_mfma_f32_16x16x32_bf16 v[68:71], v[56:59], v[64:67], v[68:71]
  ds_read_b128 v[44:47], v33 offset:28672
  ds_read_b64_tr_b16 v[56:57], v23 offset:37888
  ds_read_b64_tr_b16 v[58:59], v23 offset:38656
  ds_read_b64_tr_b16 v[60:61], v24 offset:37888
  ds_read_b64_tr_b16 v[62:63], v24 offset:38656
  s_waitcnt lgkmcnt(5)
  v_mfma_f32_32x32x16_bf16 v[72:87], v[48:51], v[40:43], v[72:87]
  s_add_u32 m0, s26, 29440
  s_mov_b32 s38, 995328
  s_mov_b64 exec, s[46:47]
  buffer_load_dwordx4 v14, s[8:11], s38 offen lds
  s_mov_b64 exec, -1
  v_mfma_f32_32x32x16_bf16 v[88:103], v[52:55], v[40:43], v[88:103]
  v_mfma_f32_16x16x32_bf16 v[68:71], v[48:51], v[64:67], v[68:71]
  v_dot2c_f32_bf16 v8, s49, v40
  v_dot2c_f32_bf16 v12, v40, v40
  v_dot2c_f32_bf16 v9, s49, v41
  v_dot2c_f32_bf16 v13, v41, v41
  v_dot2c_f32_bf16 v8, s49, v42
  v_dot2c_f32_bf16 v12, v42, v42
  v_dot2c_f32_bf16 v9, s49, v43
  v_dot2c_f32_bf16 v13, v43, v43
  s_waitcnt vmcnt(4)
  s_barrier
  ds_read_b128 v[40:43], v26 offset:0
  ds_read_b64_tr_b16 v[48:49], v20 offset:0
  ds_read_b64_tr_b16 v[50:51], v20 offset:768
  ds_read_b64_tr_b16 v[52:53], v21 offset:0
  ds_read_b64_tr_b16 v[54:55], v21 offset:768
  s_waitcnt lgkmcnt(5)
  v_mfma_f32_32x32x16_bf16 v[72:87], v[56:59], v[44:47], v[72:87]
  s_add_u32 m0, s25, 57344
  s_movk_i32 s38, 768
  buffer_load_dwordx4 v10, s[4:7], s38 offen lds
  v_mfma_f32_32x32x16_bf16 v[88:103], v[60:63], v[44:47], v[88:103]
  v_mfma_f32_16x16x32_bf16 v[68:71], v[56:59], v[64:67], v[68:71]
  ds_read_b128 v[44:47], v27 offset:0
  ds_read_b64_tr_b16 v[56:57], v20 offset:3072
  ds_read_b64_tr_b16 v[58:59], v20 offset:3840
  ds_read_b64_tr_b16 v[60:61], v21 offset:3072
  ds_read_b64_tr_b16 v[62:63], v21 offset:3840
  s_waitcnt lgkmcnt(5)
  v_mfma_f32_32x32x16_bf16 v[72:87], v[48:51], v[40:43], v[72:87]
  s_add_u32 m0, s25, 58368
  s_movk_i32 s38, 768
  buffer_load_dwordx4 v11, s[4:7], s38 offen lds
  v_mfma_f32_32x32x16_bf16 v[88:103], v[52:55], v[40:43], v[88:103]
  v_mfma_f32_16x16x32_bf16 v[68:71], v[48:51], v[64:67], v[68:71]
  v_dot2c_f32_bf16 v8, s49, v40
  v_dot2c_f32_bf16 v12, v40, v40
  v_dot2c_f32_bf16 v9, s49, v41
  v_dot2c_f32_bf16 v13, v41, v41
  v_dot2c_f32_bf16 v8, s49, v42
  v_dot2c_f32_bf16 v12, v42, v42
  v_dot2c_f32_bf16 v9, s49, v43
  v_dot2c_f32_bf16 v13, v43, v43
  ds_read_b128 v[40:43], v28 offset:0
  ds_read_b64_tr_b16 v[48:49], v20 offset:6144
  ds_read_b64_tr_b16 v[50:51], v20 offset:6912
  ds_read_b64_tr_b16 v[52:53], v21 offset:6144
  ds_read_b64_tr_b16 v[54:55], v21 offset:6912
  s_waitcnt lgkmcnt(5)
  v_mfma_f32_32x32x16_bf16 v[72:87], v[56:59], v[44:47], v[72:87]
  s_add_u32 m0, s26, 57344
  s_mov_b32 s38, 1179648
  s_mov_b64 exec, s[46:47]
  buffer_load_dwordx4 v14, s[8:11], s38 offen lds
  s_mov_b64 exec, -1
  v_mfma_f32_32x32x16_bf16 v[88:103], v[60:63], v[44:47], v[88:103]
  v_mfma_f32_16x16x32_bf16 v[68:71], v[56:59], v[64:67], v[68:71]
  ds_read_b128 v[44:47], v29 offset:0
  ds_read_b64_tr_b16 v[56:57], v20 offset:9216
  ds_read_b64_tr_b16 v[58:59], v20 offset:9984
  ds_read_b64_tr_b16 v[60:61], v21 offset:9216
  ds_read_b64_tr_b16 v[62:63], v21 offset:9984
  s_waitcnt lgkmcnt(5)
  v_mfma_f32_32x32x16_bf16 v[72:87], v[48:51], v[40:43], v[72:87]
  s_add_u32 m0, s26, 58112
  s_mov_b32 s38, 1191936
  s_mov_b64 exec, s[46:47]
  buffer_load_dwordx4 v14, s[8:11], s38 offen lds
  s_mov_b64 exec, -1
  v_mfma_f32_32x32x16_bf16 v[88:103], v[52:55], v[40:43], v[88:103]
  v_mfma_f32_16x16x32_bf16 v[68:71], v[48:51], v[64:67], v[68:71]
  v_dot2c_f32_bf16 v8, s49, v40
  v_dot2c_f32_bf16 v12, v40, v40
  v_dot2c_f32_bf16 v9, s49, v41
  v_dot2c_f32_bf16 v13, v41, v41
  v_dot2c_f32_bf16 v8, s49, v42
  v_dot2c_f32_bf16 v12, v42, v42
  v_dot2c_f32_bf16 v9, s49, v43
  v_dot2c_f32_bf16 v13, v43, v43
  s_waitcnt vmcnt(4)
  s_barrier
  ds_read_b128 v[40:43], v26 offset:28672
  ds_read_b64_tr_b16 v[48:49], v20 offset:28672
  ds_read_b64_tr_b16 v[50:51], v20 offset:29440
  ds_read_b64_tr_b16 v[52:53], v21 offset:28672
  ds_read_b64_tr_b16 v[54:55], v21 offset:29440
  s_waitcnt lgkmcnt(5)
  v_mfma_f32_32x32x16_bf16 v[72:87], v[56:59], v[44:47], v[72:87]
  s_add_u32 m0, s25, 86016
  s_movk_i32 s38, 896
  buffer_load_dwordx4 v10, s[4:7], s38 offen lds
  v_mfma_f32_32x32x16_bf16 v[88:103], v[60:63], v[44:47], v[88:103]
  v_mfma_f32_16x16x32_bf16 v[68:71], v[56:59], v[64:67], v[68:71]
  ds_read_b128 v[44:47], v27 offset:28672
  ds_read_b64_tr_b16 v[56:57], v20 offset:31744
  ds_read_b64_tr_b16 v[58:59], v20 offset:32512
  ds_read_b64_tr_b16 v[60:61], v21 offset:31744
  ds_read_b64_tr_b16 v[62:63], v21 offset:32512
  s_waitcnt lgkmcnt(5)
  v_mfma_f32_32x32x16_bf16 v[72:87], v[48:51], v[40:43], v[72:87]
  s_add_u32 m0, s25, 87040
  s_movk_i32 s38, 896
  buffer_load_dwordx4 v11, s[4:7], s38 offen lds
  v_mfma_f32_32x32x16_bf16 v[88:103], v[52:55], v[40:43], v[88:103]
  v_mfma_f32_16x16x32_bf16 v[68:71], v[48:51], v[64:67], v[68:71]
  v_dot2c_f32_bf16 v8, s49, v40
  v_dot2c_f32_bf16 v12, v40, v40
  v_dot2c_f32_bf16 v9, s49, v41
  v_dot2c_f32_bf16 v13, v41, v41
  v_dot2c_f32_bf16 v8, s49, v42
  v_dot2c_f32_bf16 v12, v42, v42
  v_dot2c_f32_bf16 v9, s49, v43
  v_dot2c_f32_bf16 v13, v43, v43
  ds_read_b128 v[40:43], v28 offset:28672
  ds_read_b64_tr_b16 v[48:49], v20 offset:34816
  ds_read_b64_tr_b16 v[50:51], v20 offset:35584
  ds_read_b64_tr_b16 v[52:53], v21 offset:34816
  ds_read_b64_tr_b16 v[54:55], v21 offset:35584
  s_waitcnt lgkmcnt(5)
  v_mfma_f32_32x32x16_bf16 v[72:87], v[56:59], v[44:47], v[72:87]
  s_add_u32 m0, s26, 86016
  s_mov_b32 s38, 1376256
  s_mov_b64 exec, s[46:47]
  buffer_load_dwordx4 v14, s[8:11], s38 offen lds
  s_mov_b64 exec, -1
  v_mfma_f32_32x32x16_bf16 v[88:103], v[60:63], v[44:47], v[88:103]
  v_mfma_f32_16x16x32_bf16 v[68:71], v[56:59], v[64:67], v[68:71]
  ds_read_b128 v[44:47], v29 offset:28672
  ds_read_b64_tr_b16 v[56:57], v20 offset:37888
  ds_read_b64_tr_b16 v[58:59], v20 offset:38656
  ds_read_b64_tr_b16 v[60:61], v21 offset:37888
  ds_read_b64_tr_b16 v[62:63], v21 offset:38656
  s_waitcnt lgkmcnt(5)
  v_mfma_f32_32x32x16_bf16 v[72:87], v[48:51], v[40:43], v[72:87]
  s_add_u32 m0, s26, 86784
  s_mov_b32 s38, 1388544
  s_mov_b64 exec, s[46:47]
  buffer_load_dwordx4 v14, s[8:11], s38 offen lds
  s_mov_b64 exec, -1
  v_mfma_f32_32x32x16_bf16 v[88:103], v[52:55], v[40:43], v[88:103]
  v_mfma_f32_16x16x32_bf16 v[68:71], v[48:51], v[64:67], v[68:71]
  v_dot2c_f32_bf16 v8, s49, v40
  v_dot2c_f32_bf16 v12, v40, v40
  v_dot2c_f32_bf16 v9, s49, v41
  v_dot2c_f32_bf16 v13, v41, v41
  v_dot2c_f32_bf16 v8, s49, v42
  v_dot2c_f32_bf16 v12, v42, v42
  v_dot2c_f32_bf16 v9, s49, v43
  v_dot2c_f32_bf16 v13, v43, v43
  s_waitcnt vmcnt(4)
  s_barrier
  ds_read_b128 v[40:43], v30 offset:0
  ds_read_b64_tr_b16 v[48:49], v23 offset:0
  ds_read_b64_tr_b16 v[50:51], v23 offset:768
  ds_read_b64_tr_b16 v[52:53], v24 offset:0
  ds_read_b64_tr_b16 v[54:55], v24 offset:768
  s_waitcnt lgkmcnt(5)
  v_mfma_f32_32x32x16_bf16 v[72:87], v[56:59], v[44:47], v[72:87]
  v_mfma_f32_32x32x16_bf16 v[88:103], v[60:63], v[44:47], v[88:103]
  v_mfma_f32_16x16x32_bf16 v[68:71], v[56:59], v[64:67], v[68:71]
  ds_read_b128 v[44:47], v31 offset:0
  ds_read_b64_tr_b16 v[56:57], v23 offset:3072
  ds_read_b64_tr_b16 v[58:59], v23 offset:3840
  ds_read_b64_tr_b16 v[60:61], v24 offset:3072
  ds_read_b64_tr_b16 v[62:63], v24 offset:3840
  s_waitcnt lgkmcnt(5)
  v_mfma_f32_32x32x16_bf16 v[72:87], v[48:51], v[40:43], v[72:87]
  v_mfma_f32_32x32x16_bf16 v[88:103], v[52:55], v[40:43], v[88:103]
  v_mfma_f32_16x16x32_bf16 v[68:71], v[48:51], v[64:67], v[68:71]
  v_dot2c_f32_bf16 v8, s49, v40
  v_dot2c_f32_bf16 v12, v40, v40
  v_dot2c_f32_bf16 v9, s49, v41
  v_dot2c_f32_bf16 v13, v41, v41
  v_dot2c_f32_bf16 v8, s49, v42
  v_dot2c_f32_bf16 v12, v42, v42
  v_dot2c_f32_bf16 v9, s49, v43
  v_dot2c_f32_bf16 v13, v43, v43
  ds_read_b128 v[40:43], v32 offset:0
  ds_read_b64_tr_b16 v[48:49], v23 offset:6144
  ds_read_b64_tr_b16 v[50:51], v23 offset:6912
  ds_read_b64_tr_b16 v[52:53], v24 offset:6144
  ds_read_b64_tr_b16 v[54:55], v24 offset:6912
  s_waitcnt lgkmcnt(5)
  v_mfma_f32_32x32x16_bf16 v[72:87], v[56:59], v[44:47], v[72:87]
  v_mfma_f32_32x32x16_bf16 v[88:103], v[60:63], v[44:47], v[88:103]
  v_mfma_f32_16x16x32_bf16 v[68:71], v[56:59], v[64:67], v[68:71]
  ds_read_b128 v[44:47], v33 offset:0
  ds_read_b64_tr_b16 v[56:57], v23 offset:9216
  ds_read_b64_tr_b16 v[58:59], v23 offset:9984
  ds_read_b64_tr_b16 v[60:61], v24 offset:9216
  ds_read_b64_tr_b16 v[62:63], v24 offset:9984
  s_waitcnt lgkmcnt(5)
  v_mfma_f32_32x32x16_bf16 v[72:87], v[48:51], v[40:43], v[72:87]
  v_mfma_f32_32x32x16_bf16 v[88:103], v[52:55], v[40:43], v[88:103]
  v_mfma_f32_16x16x32_bf16 v[68:71], v[48:51], v[64:67], v[68:71]
  v_dot2c_f32_bf16 v8, s49, v40
  v_dot2c_f32_bf16 v12, v40, v40
  v_dot2c_f32_bf16 v9, s49, v41
  v_dot2c_f32_bf16 v13, v41, v41
  v_dot2c_f32_bf16 v8, s49, v42
  v_dot2c_f32_bf16 v12, v42, v42
  v_dot2c_f32_bf16 v9, s49, v43
  v_dot2c_f32_bf16 v13, v43, v43
  s_waitcnt vmcnt(0)
  s_barrier
  ds_read_b128 v[40:43], v30 offset:28672
  ds_read_b64_tr_b16 v[48:49], v23 offset:28672
  ds_read_b64_tr_b16 v[50:51], v23 offset:29440
  ds_read_b64_tr_b16 v[52:53], v24 offset:28672
  ds_read_b64_tr_b16 v[54:55], v24 offset:29440
  s_waitcnt lgkmcnt(5)
  v_mfma_f32_32x32x16_bf16 v[72:87], v[56:59], v[44:47], v[72:87]
  v_mfma_f32_32x32x16_bf16 v[88:103], v[60:63], v[44:47], v[88:103]
  v_mfma_f32_16x16x32_bf16 v[68:71], v[56:59], v[64:67], v[68:71]
  ds_read_b128 v[44:47], v31 offset:28672
  ds_read_b64_tr_b16 v[56:57], v23 offset:31744
  ds_read_b64_tr_b16 v[58:59], v23 offset:32512
  ds_read_b64_tr_b16 v[60:61], v24 offset:31744
  ds_read_b64_tr_b16 v[62:63], v24 offset:32512
  s_waitcnt lgkmcnt(5)
  v_mfma_f32_32x32x16_bf16 v[72:87], v[48:51], v[40:43], v[72:87]
  v_mfma_f32_32x32x16_bf16 v[88:103], v[52:55], v[40:43], v[88:103]
  v_mfma_f32_16x16x32_bf16 v[68:71], v[48:51], v[64:67], v[68:71]
  v_dot2c_f32_bf16 v8, s49, v40
  v_dot2c_f32_bf16 v12, v40, v40
  v_dot2c_f32_bf16 v9, s49, v41
  v_dot2c_f32_bf16 v13, v41, v41
  v_dot2c_f32_bf16 v8, s49, v42
  v_dot2c_f32_bf16 v12, v42, v42
  v_dot2c_f32_bf16 v9, s49, v43
  v_dot2c_f32_bf16 v13, v43, v43
  ds_read_b128 v[40:43], v32 offset:28672
  ds_read_b64_tr_b16 v[48:49], v23 offset:34816
  ds_read_b64_tr_b16 v[50:51], v23 offset:35584
  ds_read_b64_tr_b16 v[52:53], v24 offset:34816
  ds_read_b64_tr_b16 v[54:55], v24 offset:35584
  s_waitcnt lgkmcnt(5)
  v_mfma_f32_32x32x16_bf16 v[72:87], v[56:59], v[44:47], v[72:87]
  v_mfma_f32_32x32x16_bf16 v[88:103], v[60:63], v[44:47], v[88:103]
  v_mfma_f32_16x16x32_bf16 v[68:71], v[56:59], v[64:67], v[68:71]
  ds_read_b128 v[44:47], v33 offset:28672
  ds_read_b64_tr_b16 v[56:57], v23 offset:37888
  ds_read_b64_tr_b16 v[58:59], v23 offset:38656
  ds_read_b64_tr_b16 v[60:61], v24 offset:37888
  ds_read_b64_tr_b16 v[62:63], v24 offset:38656
  s_waitcnt lgkmcnt(5)
  v_mfma_f32_32x32x16_bf16 v[72:87], v[48:51], v[40:43], v[72:87]
  v_mfma_f32_32x32x16_bf16 v[88:103], v[52:55], v[40:43], v[88:103]
  v_mfma_f32_16x16x32_bf16 v[68:71], v[48:51], v[64:67], v[68:71]
  v_dot2c_f32_bf16 v8, s49, v40
  v_dot2c_f32_bf16 v12, v40, v40
  v_dot2c_f32_bf16 v9, s49, v41
  v_dot2c_f32_bf16 v13, v41, v41
  v_dot2c_f32_bf16 v8, s49, v42
  v_dot2c_f32_bf16 v12, v42, v42
  v_dot2c_f32_bf16 v9, s49, v43
  v_dot2c_f32_bf16 v13, v43, v43
  s_waitcnt lgkmcnt(0)
  v_mfma_f32_32x32x16_bf16 v[72:87], v[56:59], v[44:47], v[72:87]
  v_mfma_f32_32x32x16_bf16 v[88:103], v[60:63], v[44:47], v[88:103]
  v_mfma_f32_16x16x32_bf16 v[68:71], v[56:59], v[64:67], v[68:71]
  v_and_b32 v10, 15, v1
  v_lshlrev_b32 v10, 6, v10
  v_lshrrev_b32 v11, 4, v1
  v_lshlrev_b32 v11, 4, v11
  v_add_u32 v10, v10, v11
  s_lshl_b32 s39, s27, 7
  v_add_u32 v10, s39, v10
  s_mov_b32 s46, 0x00030003
  s_mov_b32 s47, 0x00030003
  s_nop 3
  s_mov_b64 exec, s[46:47]
  ds_write_b128 v10, v[68:71] offset:4096
  s_mov_b64 exec, -1
  s_lshl_b32 s38, s21, 8
  v_lshlrev_b32 v7, 3, v2
  v_add_u32 v7, s38, v7
  s_nop 2
  v_add_f32 v8, v8, v9
  v_add_f32 v9, v12, v13
  v_mov_b32 v12, v8
  v_mov_b32 v13, v9
  s_nop 1
  v_permlane32_swap_b32 v8, v12
  v_permlane32_swap_b32 v9, v13
  s_nop 1
  v_add_f32 v8, v8, v12
  v_add_f32 v9, v9, v13
  ds_write_b64 v7, v[8:9] offset:0
  v_lshlrev_b32 v10, 4, v3
  v_lshlrev_b32 v15, 5, v2
  v_add_u32 v15, v15, v10
  s_lshl_b32 s38, s27, 7
  v_add_u32 v16, s38, v10
  s_lshl_b32 s38, s28, 7
  v_add_u32 v17, s38, v10
  s_waitcnt lgkmcnt(0)
  s_barrier
  ds_read_b64 v[12:13], v7 offset:1024
  ds_read_b128 v[120:123], v16 offset:4096
  ds_read_b128 v[124:127], v16 offset:4128
  ds_read_b128 v[26:29], v16 offset:4160
  ds_read_b128 v[30:33], v16 offset:4192
  s_waitcnt lgkmcnt(4)
  v_add_f32 v8, v8, v12
  v_add_f32 v9, v9, v13
  v_mul_f32 v22, 0x3b000000, v8
  v_mul_f32 v23, 0x3b000000, v9
  v_fma_f32 v23, -v22, v22, v23
  v_max_f32 v23, 0, v23
  v_add_f32 v23, 0x3727c5ac, v23
  v_rsq_f32 v23, v23
  s_nop 0
  v_mul_f32 v22, v22, v23
  s_waitcnt lgkmcnt(2)
  s_mul_i32 s41, s24, 6
  s_lshl_b32 s38, s27, 1
  s_add_u32 s41, s41, s38
  s_lshl_b32 s42, s41, 16
  s_lshl_b32 s43, s40, 10
  s_add_u32 s42, s42, s43
  s_cmp_lt_u32 s41, 32
  s_cselect_b32 s44, 0x3eb8aa3b, 1.0
  v_mul_f32 v11, s44, v23
  v_mul_f32 v12, s44, v22
  s_cmp_ge_u32 s41, 64
  s_cselect_b64 vcc, -1, 0
  v_cndmask_b32 v13, v4, v15, vcc
  v_mul_f32 v120, v12, v120
  v_mul_f32 v121, v12, v121
  v_mul_f32 v122, v12, v122
  v_mul_f32 v123, v12, v123
  v_mul_f32 v124, v12, v124
  v_mul_f32 v125, v12, v125
  v_mul_f32 v126, v12, v126
  v_mul_f32 v127, v12, v127
  v_fma_f32 v72, v11, v72, -v120
  v_fma_f32 v73, v11, v73, -v121
  v_fma_f32 v74, v11, v74, -v122
  v_fma_f32 v75, v11, v75, -v123
  v_fma_f32 v76, v11, v76, -v124
  v_fma_f32 v77, v11, v77, -v125
  v_fma_f32 v78, v11, v78, -v126
  v_fma_f32 v79, v11, v79, -v127
  ds_read_b128 v[120:123], v17 offset:4096
  ds_read_b128 v[124:127], v17 offset:4128
  v_cvt_pk_bf16_f32 v40, v72, v73
  v_cvt_pk_bf16_f32 v41, v74, v75
  v_cvt_pk_bf16_f32 v42, v76, v77
  v_cvt_pk_bf16_f32 v43, v78, v79
  buffer_store_dwordx4 v[40:43], v13, s[12:15], s42 offen sc1
  s_waitcnt lgkmcnt(2)
  s_mul_i32 s41, s24, 6
  s_lshl_b32 s38, s27, 1
  s_add_u32 s41, s41, s38
  s_add_u32 s41, s41, 1
  s_lshl_b32 s42, s41, 16
  s_lshl_b32 s43, s40, 10
  s_add_u32 s42, s42, s43
  s_cmp_lt_u32 s41, 32
  s_cselect_b32 s44, 0x3eb8aa3b, 1.0
  v_mul_f32 v11, s44, v23
  v_mul_f32 v12, s44, v22
  s_cmp_ge_u32 s41, 64
  s_cselect_b64 vcc, -1, 0
  v_cndmask_b32 v13, v4, v15, vcc
  v_mul_f32 v26, v12, v26
  v_mul_f32 v27, v12, v27
  v_mul_f32 v28, v12, v28
  v_mul_f32 v29, v12, v29
  v_mul_f32 v30, v12, v30
  v_mul_f32 v31, v12, v31
  v_mul_f32 v32, v12, v32
  v_mul_f32 v33, v12, v33
  v_fma_f32 v80, v11, v80, -v26
  v_fma_f32 v81, v11, v81, -v27
  v_fma_f32 v82, v11, v82, -v28
  v_fma_f32 v83, v11, v83, -v29
  v_fma_f32 v84, v11, v84, -v30
  v_fma_f32 v85, v11, v85, -v31
  v_fma_f32 v86, v11, v86, -v32
  v_fma_f32 v87, v11, v87, -v33
  ds_read_b128 v[26:29], v17 offset:4160
  ds_read_b128 v[30:33], v17 offset:4192
  v_cvt_pk_bf16_f32 v44, v80, v81
  v_cvt_pk_bf16_f32 v45, v82, v83
  v_cvt_pk_bf16_f32 v46, v84, v85
  v_cvt_pk_bf16_f32 v47, v86, v87
  buffer_store_dwordx4 v[44:47], v13, s[12:15], s42 offen sc1
  s_waitcnt lgkmcnt(2)
  s_mul_i32 s41, s24, 6
  s_lshl_b32 s38, s28, 1
  s_add_u32 s41, s41, s38
  s_lshl_b32 s42, s41, 16
  s_lshl_b32 s43, s40, 10
  s_add_u32 s42, s42, s43
  s_cmp_lt_u32 s41, 32
  s_cselect_b32 s44, 0x3eb8aa3b, 1.0
  v_mul_f32 v11, s44, v23
  v_mul_f32 v12, s44, v22
  s_cmp_ge_u32 s41, 64
  s_cselect_b64 vcc, -1, 0
  v_cndmask_b32 v13, v4, v15, vcc
  v_mul_f32 v120, v12, v120
  v_mul_f32 v121, v12, v121
  v_mul_f32 v122, v12, v122
  v_mul_f32 v123, v12, v123
  v_mul_f32 v124, v12, v124
  v_mul_f32 v125, v12, v125
  v_mul_f32 v126, v12, v126
  v_mul_f32 v127, v12, v127
  v_fma_f32 v88, v11, v88, -v120
  v_fma_f32 v89, v11, v89, -v121
  v_fma_f32 v90, v11, v90, -v122
  v_fma_f32 v91, v11, v91, -v123
  v_fma_f32 v92, v11, v92, -v124
  v_fma_f32 v93, v11, v93, -v125
  v_fma_f32 v94, v11, v94, -v126
  v_fma_f32 v95, v11, v95, -v127
  v_cvt_pk_bf16_f32 v40, v88, v89
  v_cvt_pk_bf16_f32 v41, v90, v91
  v_cvt_pk_bf16_f32 v42, v92, v93
  v_cvt_pk_bf16_f32 v43, v94, v95
  buffer_store_dwordx4 v[40:43], v13, s[12:15], s42 offen sc1
  s_waitcnt lgkmcnt(0)
  s_mul_i32 s41, s24, 6
  s_lshl_b32 s38, s28, 1
  s_add_u32 s41, s41, s38
  s_add_u32 s41, s41, 1
  s_lshl_b32 s42, s41, 16
  s_lshl_b32 s43, s40, 10
  s_add_u32 s42, s42, s43
  s_cmp_lt_u32 s41, 32
  s_cselect_b32 s44, 0x3eb8aa3b, 1.0
  v_mul_f32 v11, s44, v23
  v_mul_f32 v12, s44, v22
  s_cmp_ge_u32 s41, 64
  s_cselect_b64 vcc, -1, 0
  v_cndmask_b32 v13, v4, v15, vcc
  v_mul_f32 v26, v12, v26
  v_mul_f32 v27, v12, v27
  v_mul_f32 v28, v12, v28
  v_mul_f32 v29, v12, v29
  v_mul_f32 v30, v12, v30
  v_mul_f32 v31, v12, v31
  v_mul_f32 v32, v12, v32
  v_mul_f32 v33, v12, v33
  v_fma_f32 v96, v11, v96, -v26
  v_fma_f32 v97, v11, v97, -v27
  v_fma_f32 v98, v11, v98, -v28
  v_fma_f32 v99, v11, v99, -v29
  v_fma_f32 v100, v11, v100, -v30
  v_fma_f32 v101, v11, v101, -v31
  v_fma_f32 v102, v11, v102, -v32
  v_fma_f32 v103, v11, v103, -v33
  v_cvt_pk_bf16_f32 v44, v96, v97
  v_cvt_pk_bf16_f32 v45, v98, v99
  v_cvt_pk_bf16_f32 v46, v100, v101
  v_cvt_pk_bf16_f32 v47, v102, v103
  buffer_store_dwordx4 v[44:47], v13, s[12:15], s42 offen sc1
  s_branch L_k1_qkv_kernel_join
L_k1_qkv_kernel_roleB:
  s_waitcnt vmcnt(4)
  s_barrier
  ds_read_b128 v[40:43], v26 offset:0
  ds_read_b64_tr_b16 v[48:49], v22 offset:0
  ds_read_b64_tr_b16 v[50:51], v22 offset:768
  ds_read_b128 v[44:47], v27 offset:0
  ds_read_b64_tr_b16 v[56:57], v22 offset:3072
  ds_read_b64_tr_b16 v[58:59], v22 offset:3840
  s_waitcnt lgkmcnt(3)
  v_mfma_f32_32x32x16_bf16 v[72:87], v[48:51], v[40:43], v[72:87]
  s_add_u32 m0, s25, 57344
  s_movk_i32 s38, 256
  buffer_load_dwordx4 v10, s[4:7], s38 offen lds
  s_add_u32 m0, s25, 58368
  s_movk_i32 s38, 256
  buffer_load_dwordx4 v11, s[4:7], s38 offen lds
  ds_read_b128 v[40:43], v28 offset:0
  ds_read_b64_tr_b16 v[48:49], v22 offset:6144
  ds_read_b64_tr_b16 v[50:51], v22 offset:6912
  s_waitcnt lgkmcnt(3)
  v_mfma_f32_32x32x16_bf16 v[72:87], v[56:59], v[44:47], v[72:87]
  s_add_u32 m0, s26, 57344
  s_mov_b32 s38, 393216
  s_mov_b64 exec, s[46:47]
  buffer_load_dwordx4 v14, s[8:11], s38 offen lds
  s_mov_b64 exec, -1
  v_dot2c_f32_bf16 v8, s49, v44
  v_dot2c_f32_bf16 v12, v44, v44
  v_dot2c_f32_bf16 v9, s49, v45
  v_dot2c_f32_bf16 v13, v45, v45
  v_dot2c_f32_bf16 v8, s49, v46
  v_dot2c_f32_bf16 v12, v46, v46
  v_dot2c_f32_bf16 v9, s49, v47
  v_dot2c_f32_bf16 v13, v47, v47
  ds_read_b128 v[44:47], v29 offset:0
  ds_read_b64_tr_b16 v[56:57], v22 offset:9216
  ds_read_b64_tr_b16 v[58:59], v22 offset:9984
  s_waitcnt lgkmcnt(3)
  v_mfma_f32_32x32x16_bf16 v[72:87], v[48:51], v[40:43], v[72:87]
  s_add_u32 m0, s26, 58112
  s_mov_b32 s38, 405504
  s_mov_b64 exec, s[46:47]
  buffer_load_dwordx4 v14, s[8:11], s38 offen lds
  s_mov_b64 exec, -1
  s_waitcnt vmcnt(4)
  s_barrier
  ds_read_b128 v[40:43], v26 offset:28672
  ds_read_b64_tr_b16 v[48:49], v22 offset:28672
  ds_read_b64_tr_b16 v[50:51], v22 offset:29440
  s_waitcnt lgkmcnt(3)
  v_mfma_f32_32x32x16_bf16 v[72:87], v[56:59], v[44:47], v[72:87]
  s_add_u32 m0, s25, 86016
  s_movk_i32 s38, 384
  buffer_load_dwordx4 v10, s[4:7], s38 offen lds
  v_dot2c_f32_bf16 v8, s49, v44
  v_dot2c_f32_bf16 v12, v44, v44
  v_dot2c_f32_bf16 v9, s49, v45
  v_dot2c_f32_bf16 v13, v45, v45
  v_dot2c_f32_bf16 v8, s49, v46
  v_dot2c_f32_bf16 v12, v46, v46
  v_dot2c_f32_bf16 v9, s49, v47
  v_dot2c_f32_bf16 v13, v47, v47
  ds_read_b128 v[44:47], v27 offset:28672
  ds_read_b64_tr_b16 v[56:57], v22 offset:31744
  ds_read_b64_tr_b16 v[58:59], v22 offset:32512
  s_waitcnt lgkmcnt(3)
  v_mfma_f32_32x32x16_bf16 v[72:87], v[48:51], v[40:43], v[72:87]
  s_add_u32 m0, s25, 87040
  s_movk_i32 s38, 384
  buffer_load_dwordx4 v11, s[4:7], s38 offen lds
  ds_read_b128 v[40:43], v28 offset:28672
  ds_read_b64_tr_b16 v[48:49], v22 offset:34816
  ds_read_b64_tr_b16 v[50:51], v22 offset:35584
  s_waitcnt lgkmcnt(3)
  v_mfma_f32_32x32x16_bf16 v[72:87], v[56:59], v[44:47], v[72:87]
  s_add_u32 m0, s26, 86016
  s_mov_b32 s38, 589824
  s_mov_b64 exec, s[46:47]
  buffer_load_dwordx4 v14, s[8:11], s38 offen lds
  s_mov_b64 exec, -1
  v_dot2c_f32_bf16 v8, s49, v44
  v_dot2c_f32_bf16 v12, v44, v44
  v_dot2c_f32_bf16 v9, s49, v45
  v_dot2c_f32_bf16 v13, v45, v45
  v_dot2c_f32_bf16 v8, s49, v46
  v_dot2c_f32_bf16 v12, v46, v46
  v_dot2c_f32_bf16 v9, s49, v47
  v_dot2c_f32_bf16 v13, v47, v47
  ds_read_b128 v[44:47], v29 offset:28672
  ds_read_b64_tr_b16 v[56:57], v22 offset:37888
  ds_read_b64_tr_b16 v[58:59], v22 offset:38656
  s_waitcnt lgkmcnt(3)
  v_mfma_f32_32x32x16_bf16 v[72:87], v[48:51], v[40:43], v[72:87]
  s_add_u32 m0, s26, 86784
  s_mov_b32 s38, 602112
  s_mov_b64 exec, s[46:47]
  buffer_load_dwordx4 v14, s[8:11], s38 offen lds
  s_mov_b64 exec, -1
  s_waitcnt vmcnt(4)
  s_barrier
  ds_read_b128 v[40:43], v30 offset:0
  ds_read_b64_tr_b16 v[48:49], v25 offset:0
  ds_read_b64_tr_b16 v[50:51], v25 offset:768
  s_waitcnt lgkmcnt(3)
  v_mfma_f32_32x32x16_bf16 v[72:87], v[56:59], v[44:47], v[72:87]
  s_add_u32 m0, s25, 0
  s_movk_i32 s38, 512
  buffer_load_dwordx4 v10, s[4:7], s38 offen lds
  v_dot2c_f32_bf16 v8, s49, v44
  v_dot2c_f32_bf16 v12, v44, v44
  v_dot2c_f32_bf16 v9, s49, v45
  v_dot2c_f32_bf16 v13, v45, v45
  v_dot2c_f32_bf16 v8, s49, v46
  v_dot2c_f32_bf16 v12, v46, v46
  v_dot2c_f32_bf16 v9, s49, v47
  v_dot2c_f32_bf16 v13, v47, v47
  ds_read_b128 v[44:47], v31 offset:0
  ds_read_b64_tr_b16 v[56:57], v25 offset:3072
  ds_read_b64_tr_b16 v[58:59], v25 offset:3840
  s_waitcnt lgkmcnt(3)
  v_mfma_f32_32x32x16_bf16 v[72:87], v[48:51], v[40:43], v[72:87]
  s_add_u32 m0, s25, 1024
  s_movk_i32 s38, 512
  buffer_load_dwordx4 v11, s[4:7], s38 offen lds
  ds_read_b128 v[40:43], v32 offset:0
  ds_read_b64_tr_b16 v[48:49], v25 offset:6144
  ds_read_b64_tr_b16 v[50:51], v25 offset:6912
  s_waitcnt lgkmcnt(3)
  v_mfma_f32_32x32x16_bf16 v[72:87], v[56:59], v[44:47], v[72:87]
  s_add_u32 m0, s26, 0
  s_mov_b32 s38, 786432
  s_mov_b64 exec, s[46:47]
  buffer_load_dwordx4 v14, s[8:11], s38 offen lds
  s_mov_b64 exec, -1
  v_dot2c_f32_bf16 v8, s49, v44
  v_dot2c_f32_bf16 v12, v44, v44
  v_dot2c_f32_bf16 v9, s49, v45
  v_dot2c_f32_bf16 v13, v45, v45
  v_dot2c_f32_bf16 v8, s49, v46
  v_dot2c_f32_bf16 v12, v46, v46
  v_dot2c_f32_bf16 v9, s49, v47
  v_dot2c_f32_bf16 v13, v47, v47
  ds_read_b128 v[44:47], v33 offset:0
  ds_read_b64_tr_b16 v[56:57], v25 offset:9216
  ds_read_b64_tr_b16 v[58:59], v25 offset:9984
  s_waitcnt lgkmcnt(3)
  v_mfma_f32_32x32x16_bf16 v[72:87], v[48:51], v[40:43], v[72:87]
  s_add_u32 m0, s26, 768
  s_mov_b32 s38, 798720
  s_mov_b64 exec, s[46:47]
  buffer_load_dwordx4 v14, s[8:11], s38 offen lds
  s_mov_b64 exec, -1
  s_waitcnt vmcnt(4)
  s_barrier
  ds_read_b128 v[40:43], v30 offset:28672
  ds_read_b64_tr_b16 v[48:49], v25 offset:28672
  ds_read_b64_tr_b16 v[50:51], v25 offset:29440
  s_waitcnt lgkmcnt(3)
  v_mfma_f32_32x32x16_bf16 v[72:87], v[56:59], v[44:47], v[72:87]
  s_add_u32 m0, s25, 28672
  s_movk_i32 s38, 640
  buffer_load_dwordx4 v10, s[4:7], s38 offen lds
  v_dot2c_f32_bf16 v8, s49, v44
  v_dot2c_f32_bf16 v12, v44, v44
  v_dot2c_f32_bf16 v9, s49, v45
  v_dot2c_f32_bf16 v13, v45, v45
  v_dot2c_f32_bf16 v8, s49, v46
  v_dot2c_f32_bf16 v12, v46, v46
  v_dot2c_f32_bf16 v9, s49, v47
  v_dot2c_f32_bf16 v13, v47, v47
  ds_read_b128 v[44:47], v31 offset:28672
  ds_read_b64_tr_b16 v[56:57], v25 offset:31744
  ds_read_b64_tr_b16 v[58:59], v25 offset:32512
  s_waitcnt lgkmcnt(3)
  v_mfma_f32_32x32x16_bf16 v[72:87], v[48:51], v[40:43], v[72:87]
  s_add_u32 m0, s25, 29696
  s_movk_i32 s38, 640
  buffer_load_dwordx4 v11, s[4:7], s38 offen lds
  ds_read_b128 v[40:43], v32 offset:28672
  ds_read_b64_tr_b16 v[48:49], v25 offset:34816
  ds_read_b64_tr_b16 v[50:51], v25 offset:35584
  s_waitcnt lgkmcnt(3)
  v_mfma_f32_32x32x16_bf16 v[72:87], v[56:59], v[44:47], v[72:87]
  s_add_u32 m0, s26, 28672
  s_mov_b32 s38, 983040
  s_mov_b64 exec, s[46:47]
  buffer_load_dwordx4 v14, s[8:11], s38 offen lds
  s_mov_b64 exec, -1
  v_dot2c_f32_bf16 v8, s49, v44
  v_dot2c_f32_bf16 v12, v44, v44
  v_dot2c_f32_bf16 v9, s49, v45
  v_dot2c_f32_bf16 v13, v45, v45
  v_dot2c_f32_bf16 v8, s49, v46
  v_dot2c_f32_bf16 v12, v46, v46
  v_dot2c_f32_bf16 v9, s49, v47
  v_dot2c_f32_bf16 v13, v47, v47
  ds_read_b128 v[44:47], v33 offset:28672
  ds_read_b64_tr_b16 v[56:57], v25 offset:37888
  ds_read_b64_tr_b16 v[58:59], v25 offset:38656
  s_waitcnt lgkmcnt(3)
  v_mfma_f32_32x32x16_bf16 v[72:87], v[48:51], v[40:43], v[72:87]
  s_add_u32 m0, s26, 29440
  s_mov_b32 s38, 995328
  s_mov_b64 exec, s[46:47]
  buffer_load_dwordx4 v14, s[8:11], s38 offen lds
  s_mov_b64 exec, -1
  s_waitcnt vmcnt(4)
  s_barrier
  ds_read_b128 v[40:43], v26 offset:0
  ds_read_b64_tr_b16 v[48:49], v22 offset:0
  ds_read_b64_tr_b16 v[50:51], v22 offset:768
  s_waitcnt lgkmcnt(3)
  v_mfma_f32_32x32x16_bf16 v[72:87], v[56:59], v[44:47], v[72:87]
  s_add_u32 m0, s25, 57344
  s_movk_i32 s38, 768
  buffer_load_dwordx4 v10, s[4:7], s38 offen lds
  v_dot2c_f32_bf16 v8, s49, v44
  v_dot2c_f32_bf16 v12, v44, v44
  v_dot2c_f32_bf16 v9, s49, v45
  v_dot2c_f32_bf16 v13, v45, v45
  v_dot2c_f32_bf16 v8, s49, v46
  v_dot2c_f32_bf16 v12, v46, v46
  v_dot2c_f32_bf16 v9, s49, v47
  v_dot2c_f32_bf16 v13, v47, v47
  ds_read_b128 v[44:47], v27 offset:0
  ds_read_b64_tr_b16 v[56:57], v22 offset:3072
  ds_read_b64_tr_b16 v[58:59], v22 offset:3840
  s_waitcnt lgkmcnt(3)
  v_mfma_f32_32x32x16_bf16 v[72:87], v[48:51], v[40:43], v[72:87]
  s_add_u32 m0, s25, 58368
  s_movk_i32 s38, 768
  buffer_load_dwordx4 v11, s[4:7], s38 offen lds
  ds_read_b128 v[40:43], v28 offset:0
  ds_read_b64_tr_b16 v[48:49], v22 offset:6144
  ds_read_b64_tr_b16 v[50:51], v22 offset:6912
  s_waitcnt lgkmcnt(3)
  v_mfma_f32_32x32x16_bf16 v[72:87], v[56:59], v[44:47], v[72:87]
  s_add_u32 m0, s26, 57344
  s_mov_b32 s38, 1179648
  s_mov_b64 exec, s[46:47]
  buffer_load_dwordx4 v14, s[8:11], s38 offen lds
  s_mov_b64 exec, -1
  v_dot2c_f32_bf16 v8, s49, v44
  v_dot2c_f32_bf16 v12, v44, v44
  v_dot2c_f32_bf16 v9, s49, v45
  v_dot2c_f32_bf16 v13, v45, v45
  v_dot2c_f32_bf16 v8, s49, v46
  v_dot2c_f32_bf16 v12, v46, v46
  v_dot2c_f32_bf16 v9, s49, v47
  v_dot2c_f32_bf16 v13, v47, v47
  ds_read_b128 v[44:47], v29 offset:0
  ds_read_b64_tr_b16 v[56:57], v22 offset:9216
  ds_read_b64_tr_b16 v[58:59], v22 offset:9984
  s_waitcnt lgkmcnt(3)
  v_mfma_f32_32x32x16_bf16 v[72:87], v[48:51], v[40:43], v[72:87]
  s_add_u32 m0, s26, 58112
  s_mov_b32 s38, 1191936
  s_mov_b64 exec, s[46:47]
  buffer_load_dwordx4 v14, s[8:11], s38 offen lds
  s_mov_b64 exec, -1
  s_waitcnt vmcnt(4)
  s_barrier
  ds_read_b128 v[40:43], v26 offset:28672
  ds_read_b64_tr_b16 v[48:49], v22 offset:28672
  ds_read_b64_tr_b16 v[50:51], v22 offset:29440
  s_waitcnt lgkmcnt(3)
  v_mfma_f32_32x32x16_bf16 v[72:87], v[56:59], v[44:47], v[72:87]
  s_add_u32 m0, s25, 86016
  s_movk_i32 s38, 896
  buffer_load_dwordx4 v10, s[4:7], s38 offen lds
  v_dot2c_f32_bf16 v8, s49, v44
  v_dot2c_f32_bf16 v12, v44, v44
  v_dot2c_f32_bf16 v9, s49, v45
  v_dot2c_f32_bf16 v13, v45, v45
  v_dot2c_f32_bf16 v8, s49, v46
  v_dot2c_f32_bf16 v12, v46, v46
  v_dot2c_f32_bf16 v9, s49, v47
  v_dot2c_f32_bf16 v13, v47, v47
  ds_read_b128 v[44:47], v27 offset:28672
  ds_read_b64_tr_b16 v[56:57], v22 offset:31744
  ds_read_b64_tr_b16 v[58:59], v22 offset:32512
  s_waitcnt lgkmcnt(3)
  v_mfma_f32_32x32x16_bf16 v[72:87], v[48:51], v[40:43], v[72:87]
  s_add_u32 m0, s25, 87040
  s_movk_i32 s38, 896
  buffer_load_dwordx4 v11, s[4:7], s38 offen lds
  ds_read_b128 v[40:43], v28 offset:28672
  ds_read_b64_tr_b16 v[48:49], v22 offset:34816
  ds_read_b64_tr_b16 v[50:51], v22 offset:35584
  s_waitcnt lgkmcnt(3)
  v_mfma_f32_32x32x16_bf16 v[72:87], v[56:59], v[44:47], v[72:87]
  s_add_u32 m0, s26, 86016
  s_mov_b32 s38, 1376256
  s_mov_b64 exec, s[46:47]
  buffer_load_dwordx4 v14, s[8:11], s38 offen lds
  s_mov_b64 exec, -1
  v_dot2c_f32_bf16 v8, s49, v44
  v_dot2c_f32_bf16 v12, v44, v44
  v_dot2c_f32_bf16 v9, s49, v45
  v_dot2c_f32_bf16 v13, v45, v45
  v_dot2c_f32_bf16 v8, s49, v46
  v_dot2c_f32_bf16 v12, v46, v46
  v_dot2c_f32_bf16 v9, s49, v47
  v_dot2c_f32_bf16 v13, v47, v47
  ds_read_b128 v[44:47], v29 offset:28672
  ds_read_b64_tr_b16 v[56:57], v22 offset:37888
  ds_read_b64_tr_b16 v[58:59], v22 offset:38656
  s_waitcnt lgkmcnt(3)
  v_mfma_f32_32x32x16_bf16 v[72:87], v[48:51], v[40:43], v[72:87]
  s_add_u32 m0, s26, 86784
  s_mov_b32 s38, 1388544
  s_mov_b64 exec, s[46:47]
  buffer_load_dwordx4 v14, s[8:11], s38 offen lds
  s_mov_b64 exec, -1
  s_waitcnt vmcnt(4)
  s_barrier
  ds_read_b128 v[40:43], v30 offset:0
  ds_read_b64_tr_b16 v[48:49], v25 offset:0
  ds_read_b64_tr_b16 v[50:51], v25 offset:768
  s_waitcnt lgkmcnt(3)
  v_mfma_f32_32x32x16_bf16 v[72:87], v[56:59], v[44:47], v[72:87]
  v_dot2c_f32_bf16 v8, s49, v44
  v_dot2c_f32_bf16 v12, v44, v44
  v_dot2c_f32_bf16 v9, s49, v45
  v_dot2c_f32_bf16 v13, v45, v45
  v_dot2c_f32_bf16 v8, s49, v46
  v_dot2c_f32_bf16 v12, v46, v46
  v_dot2c_f32_bf16 v9, s49, v47
  v_dot2c_f32_bf16 v13, v47, v47
  ds_read_b128 v[44:47], v31 offset:0
  ds_read_b64_tr_b16 v[56:57], v25 offset:3072
  ds_read_b64_tr_b16 v[58:59], v25 offset:3840
  s_waitcnt lgkmcnt(3)
  v_mfma_f32_32x32x16_bf16 v[72:87], v[48:51], v[40:43], v[72:87]
  ds_read_b128 v[40:43], v32 offset:0
  ds_read_b64_tr_b16 v[48:49], v25 offset:6144
  ds_read_b64_tr_b16 v[50:51], v25 offset:6912
  s_waitcnt lgkmcnt(3)
  v_mfma_f32_32x32x16_bf16 v[72:87], v[56:59], v[44:47], v[72:87]
  v_dot2c_f32_bf16 v8, s49, v44
  v_dot2c_f32_bf16 v12, v44, v44
  v_dot2c_f32_bf16 v9, s49, v45
  v_dot2c_f32_bf16 v13, v45, v45
  v_dot2c_f32_bf16 v8, s49, v46
  v_dot2c_f32_bf16 v12, v46, v46
  v_dot2c_f32_bf16 v9, s49, v47
  v_dot2c_f32_bf16 v13, v47, v47
  ds_read_b128 v[44:47], v33 offset:0
  ds_read_b64_tr_b16 v[56:57], v25 offset:9216
  ds_read_b64_tr_b16 v[58:59], v25 offset:9984
  s_waitcnt lgkmcnt(3)
  v_mfma_f32_32x32x16_bf16 v[72:87], v[48:51], v[40:43], v[72:87]
  s_waitcnt vmcnt(0)
  s_barrier
  ds_read_b128 v[40:43], v30 offset:28672
  ds_read_b64_tr_b16 v[48:49], v25 offset:28672
  ds_read_b64_tr_b16 v[50:51], v25 offset:29440
  s_waitcnt lgkmcnt(3)
  v_mfma_f32_32x32x16_bf16 v[72:87], v[56:59], v[44:47], v[72:87]
  v_dot2c_f32_bf16 v8, s49, v44
  v_dot2c_f32_bf16 v12, v44, v44
  v_dot2c_f32_bf16 v9, s49, v45
  v_dot2c_f32_bf16 v13, v45, v45
  v_dot2c_f32_bf16 v8, s49, v46
  v_dot2c_f32_bf16 v12, v46, v46
  v_dot2c_f32_bf16 v9, s49, v47
  v_dot2c_f32_bf16 v13, v47, v47
  ds_read_b128 v[44:47], v31 offset:28672
  ds_read_b64_tr_b16 v[56:57], v25 offset:31744
  ds_read_b64_tr_b16 v[58:59], v25 offset:32512
  s_waitcnt lgkmcnt(3)
  v_mfma_f32_32x32x16_bf16 v[72:87], v[48:51], v[40:43], v[72:87]
  ds_read_b128 v[40:43], v32 offset:28672
  ds_read_b64_tr_b16 v[48:49], v25 offset:34816
  ds_read_b64_tr_b16 v[50:51], v25 offset:35584
  s_waitcnt lgkmcnt(3)
  v_mfma_f32_32x32x16_bf16 v[72:87], v[56:59], v[44:47], v[72:87]
  v_dot2c_f32_bf16 v8, s49, v44
  v_dot2c_f32_bf16 v12, v44, v44
  v_dot2c_f32_bf16 v9, s49, v45
  v_dot2c_f32_bf16 v13, v45, v45
  v_dot2c_f32_bf16 v8, s49, v46
  v_dot2c_f32_bf16 v12, v46, v46
  v_dot2c_f32_bf16 v9, s49, v47
  v_dot2c_f32_bf16 v13, v47, v47
  ds_read_b128 v[44:47], v33 offset:28672
  ds_read_b64_tr_b16 v[56:57], v25 offset:37888
  ds_read_b64_tr_b16 v[58:59], v25 offset:38656
  s_waitcnt lgkmcnt(3)
  v_mfma_f32_32x32x16_bf16 v[72:87], v[48:51], v[40:43], v[72:87]
  s_waitcnt lgkmcnt(0)
  v_mfma_f32_32x32x16_bf16 v[72:87], v[56:59], v[44:47], v[72:87]
  v_dot2c_f32_bf16 v8, s49, v44
  v_dot2c_f32_bf16 v12, v44, v44
  v_dot2c_f32_bf16 v9, s49, v45
  v_dot2c_f32_bf16 v13, v45, v45
  v_dot2c_f32_bf16 v8, s49, v46
  v_dot2c_f32_bf16 v12, v46, v46
  v_dot2c_f32_bf16 v9, s49, v47
  v_dot2c_f32_bf16 v13, v47, v47
  s_lshl_b32 s38, s21, 8
  v_lshlrev_b32 v7, 3, v2
  v_add_u32 v7, s38, v7
  s_nop 2
  v_add_f32 v8, v8, v9
  v_add_f32 v9, v12, v13
  v_mov_b32 v12, v8
  v_mov_b32 v13, v9
  s_nop 1
  v_permlane32_swap_b32 v8, v12
  v_permlane32_swap_b32 v9, v13
  s_nop 1
  v_add_f32 v8, v8, v12
  v_add_f32 v9, v9, v13
  ds_write_b64 v7, v[8:9] offset:1024
  v_lshlrev_b32 v10, 4, v3
  v_lshlrev_b32 v15, 5, v2
  v_add_u32 v15, v15, v10
  s_lshl_b32 s38, s29, 7
  v_add_u32 v16, s38, v10
  s_waitcnt lgkmcnt(0)
  s_barrier
  ds_read_b64 v[12:13], v7 offset:0
  ds_read_b128 v[120:123], v16 offset:4096
  ds_read_b128 v[124:127], v16 offset:4128
  ds_read_b128 v[26:29], v16 offset:4160
  ds_read_b128 v[30:33], v16 offset:4192
  s_waitcnt lgkmcnt(4)
  v_add_f32 v8, v8, v12
  v_add_f32 v9, v9, v13
  v_mul_f32 v22, 0x3b000000, v8
  v_mul_f32 v23, 0x3b000000, v9
  v_fma_f32 v23, -v22, v22, v23
  v_max_f32 v23, 0, v23
  v_add_f32 v23, 0x3727c5ac, v23
  v_rsq_f32 v23, v23
  s_nop 0
  v_mul_f32 v22, v22, v23
  s_waitcnt lgkmcnt(2)
  s_mul_i32 s41, s24, 6
  s_lshl_b32 s38, s29, 1
  s_add_u32 s41, s41, s38
  s_lshl_b32 s42, s41, 16
  s_lshl_b32 s43, s40, 10
  s_add_u32 s42, s42, s43
  s_cmp_lt_u32 s41, 32
  s_cselect_b32 s44, 0x3eb8aa3b, 1.0
  v_mul_f32 v11, s44, v23
  v_mul_f32 v12, s44, v22
  s_cmp_ge_u32 s41, 64
  s_cselect_b64 vcc, -1, 0
  v_cndmask_b32 v13, v4, v15, vcc
  v_mul_f32 v120, v12, v120
  v_mul_f32 v121, v12, v121
  v_mul_f32 v122, v12, v122
  v_mul_f32 v123, v12, v123
  v_mul_f32 v124, v12, v124
  v_mul_f32 v125, v12, v125
  v_mul_f32 v126, v12, v126
  v_mul_f32 v127, v12, v127
  v_fma_f32 v72, v11, v72, -v120
  v_fma_f32 v73, v11, v73, -v121
  v_fma_f32 v74, v11, v74, -v122
  v_fma_f32 v75, v11, v75, -v123
  v_fma_f32 v76, v11, v76, -v124
  v_fma_f32 v77, v11, v77, -v125
  v_fma_f32 v78, v11, v78, -v126
  v_fma_f32 v79, v11, v79, -v127
  v_cvt_pk_bf16_f32 v40, v72, v73
  v_cvt_pk_bf16_f32 v41, v74, v75
  v_cvt_pk_bf16_f32 v42, v76, v77
  v_cvt_pk_bf16_f32 v43, v78, v79
  buffer_store_dwordx4 v[40:43], v13, s[12:15], s42 offen sc1
  s_waitcnt lgkmcnt(0)
  s_mul_i32 s41, s24, 6
  s_lshl_b32 s38, s29, 1
  s_add_u32 s41, s41, s38
  s_add_u32 s41, s41, 1
  s_lshl_b32 s42, s41, 16
  s_lshl_b32 s43, s40, 10
  s_add_u32 s42, s42, s43
  s_cmp_lt_u32 s41, 32
  s_cselect_b32 s44, 0x3eb8aa3b, 1.0
  v_mul_f32 v11, s44, v23
  v_mul_f32 v12, s44, v22
  s_cmp_ge_u32 s41, 64
  s_cselect_b64 vcc, -1, 0
  v_cndmask_b32 v13, v4, v15, vcc
  v_mul_f32 v26, v12, v26
  v_mul_f32 v27, v12, v27
  v_mul_f32 v28, v12, v28
  v_mul_f32 v29, v12, v29
  v_mul_f32 v30, v12, v30
  v_mul_f32 v31, v12, v31
  v_mul_f32 v32, v12, v32
  v_mul_f32 v33, v12, v33
  v_fma_f32 v80, v11, v80, -v26
  v_fma_f32 v81, v11, v81, -v27
  v_fma_f32 v82, v11, v82, -v28
  v_fma_f32 v83, v11, v83, -v29
  v_fma_f32 v84, v11, v84, -v30
  v_fma_f32 v85, v11, v85, -v31
  v_fma_f32 v86, v11, v86, -v32
  v_fma_f32 v87, v11, v87, -v33
  v_cvt_pk_bf16_f32 v44, v80, v81
  v_cvt_pk_bf16_f32 v45, v82, v83
  v_cvt_pk_bf16_f32 v46, v84, v85
  v_cvt_pk_bf16_f32 v47, v86, v87
  buffer_store_dwordx4 v[44:47], v13, s[12:15], s42 offen sc1
L_k1_qkv_kernel_join:
  s_add_u32 s52, s34, 17825792
  s_addc_u32 s53, s35, 0
  s_mov_b32 s54, 8192
  s_mov_b32 s55, 0x00020000
  s_waitcnt vmcnt(0)
  s_barrier
  s_cmp_eq_u32 s20, 0
  s_cbranch_scc0 L_sig_c1
  s_lshl_b32 s56, s24, 7
  s_add_u32 s56, s56, 6144
  v_mov_b32 v5, 0
  v_mov_b32 v6, 1
  s_mov_b64 exec, 1
  buffer_atomic_add v6, v5, s[52:55], s56 offen sc1
  s_mov_b64 exec, -1
L_sig_c1:
  s_branch L_attn_start
L_helper:
  s_load_dwordx2 s[30:31], s[0:1], 64
  s_load_dwordx2 s[34:35], s[0:1], 72
  v_and_b32 v1, 63, v0
  v_lshlrev_b32 v5, 7, v1
  v_mov_b32 v6, 0
  v_mov_b32 v7, 1
  v_mov_b32 v8, 0
  s_waitcnt lgkmcnt(0)
  s_mov_b32 s4, s30
  s_mov_b32 s5, s31
  s_mov_b32 s6, 256
  s_mov_b32 s7, 0x00020000
  s_add_u32 s52, s34, 17825792
  s_addc_u32 s53, s35, 0
  s_mov_b32 s54, 8192
  s_mov_b32 s55, 0x00020000
  s_lshl_b32 s21, s2, 5
  s_add_u32 s21, s21, s20
  s_cmp_eq_u32 s21, 8
  s_cbranch_scc0 L_hp_z
  buffer_store_dword v6, v5, s[52:55], 0 offen sc1
L_hp_z:
  s_barrier
  s_barrier
  s_barrier
  s_cmp_eq_u32 s21, 8
  s_cbranch_scc0 L_hp_f
  s_waitcnt vmcnt(0)
  s_mov_b64 exec, 1
  buffer_store_dword v7, v6, s[4:7], 0 offen sc1
  s_mov_b64 exec, -1
L_hp_f:
  s_barrier
  s_barrier
  s_cmp_eq_u32 s20, 8
  s_cbranch_scc0 L_hp_l
  buffer_load_dword v8, v6, s[4:7], 0 offen sc1
L_hp_l:
  s_barrier
  s_barrier
  s_barrier
  s_barrier
  s_cmp_eq_u32 s20, 8
  s_cbranch_scc0 L_hp_c
  s_mov_b32 s57, 0
L_hp_spin:
  s_waitcnt vmcnt(0)
  v_readfirstlane_b32 s38, v8
  s_add_u32 s57, s57, 1
  s_cmp_ge_u32 s57, 40000
  s_cbranch_scc1 L_hp_c
  s_cmp_eq_u32 s38, 1
  s_cbranch_scc1 L_hp_c
  buffer_load_dword v8, v6, s[4:7], 0 offen sc1
  s_branch L_hp_spin
L_hp_c:
  s_barrier
  s_barrier
L_attn_start:
  s_load_dwordx2 s[30:31], s[0:1], 72
  s_load_dwordx2 s[44:45], s[0:1], 16
  s_load_dwordx2 s[46:47], s[0:1], 32
  s_load_dwordx2 s[48:49], s[0:1], 48
  s_and_b32 s23, s2, 7
  s_lshr_b32 s38, s2, 3
  s_and_b32 s38, s38, 3
  s_lshl_b32 s38, s38, 3
  s_add_u32 s23, s23, s38
  s_lshr_b32 s24, s2, 5
  v_and_b32 v1, 63, v0
  v_lshrrev_b32 v2, 6, v0
  s_nop 0
  v_readfirstlane_b32 s20, v2
  s_nop 3
  s_and_b32 s21, s20, 7
  s_lshr_b32 s22, s20, 3
  v_lshlrev_b32 v4, 4, v1
  s_lshr_b32 s38, s20, 1
  s_and_b32 s38, s38, 1
  s_lshl_b32 s38, s38, 5
  s_lshr_b32 s35, s20, 2
  s_lshl_b32 s39, s35, 3
  s_add_u32 s38, s38, s39
  s_lshl_b32 s38, s38, 10
  s_and_b32 s39, s20, 1
  s_lshl_b32 s25, s39, 16
  s_add_u32 s25, s25, s38
  s_lshl_b32 s26, s39, 21
  s_add_u32 s26, s26, s38
  s_lshl_b32 s39, s23, 16
  s_add_u32 s26, s26, s39
  s_lshl_b32 s27, s24, 3
  s_add_u32 s27, s27, s21
  s_lshl_b32 s28, s27, 10
  s_add_u32 s28, s28, s39
  s_waitcnt lgkmcnt(0)
  s_add_u32 s4, s30, 2097152
  s_addc_u32 s5, s31, 0
  s_mov_b32 s6, 4194304
  s_mov_b32 s7, 0x00020000
  s_mov_b32 s8, s30
  s_mov_b32 s9, s31
  s_mov_b32 s10, 2097152
  s_mov_b32 s11, 0x00020000
  s_add_u32 s12, s30, 6291456
  s_addc_u32 s13, s31, 0
  s_mov_b32 s14, 2097152
  s_mov_b32 s15, 0x00020000
  s_mov_b32 s40, s44
  s_mov_b32 s41, s45
  s_mov_b32 s42, 524288
  s_mov_b32 s43, 0x00020000
  s_lshr_b32 s51, s2, 3
  s_lshl_b32 s51, s51, 4
  s_add_u32 s51, s51, s20
  s_lshl_b32 s51, s51, 10
  s_mov_b32 s50, s51
  v_and_b32 v6, 5, v0
  v_cmp_eq_u32 vcc, 0, v6
  v_mov_b32 v5, 0x3f80
  v_cndmask_b32 v5, 0, v5, vcc
  v_lshlrev_b32 v6, 2, v0
  v_add_u32 v6, 131072, v6
  ds_write_b32 v6, v5
  ds_write_b32 v6, v5 offset:512
  s_lshl_b32 s29, s22, 15
  v_add_u32 v2, s29, v4
  v_lshrrev_b32 v5, 5, v1
  v_and_b32 v6, 15, v1
  v_lshlrev_b32 v6, 3, v6
  v_lshlrev_b32 v3, 7, v5
  v_add_u32 v3, v3, v6
  v_xor_b32 v7, 128, v3
  v_add_u32 v7, 131072, v7
  s_add_u32 s38, s29, 65536
  v_add_u32 v3, s38, v3
  v_and_b32 v6, 16, v1
  v_cmp_ne_u32 vcc, 0, v6
  s_nop 1
  v_cndmask_b32 v3, v3, v7, vcc
  v_mov_b32 v6, 4096
  v_cndmask_b32 v7, v6, 0, vcc
  v_mov_b32 v5, v3
  v_mov_b32 v6, v2
  s_mov_b32 s33, 0
  v_mov_b32 v116, 0
  v_mov_b32 v84, 0
  v_mov_b32 v85, 0
  v_mov_b32 v86, 0
  v_mov_b32 v87, 0
  v_mov_b32 v88, 0
  v_mov_b32 v89, 0
  v_mov_b32 v90, 0
  v_mov_b32 v91, 0
  v_mov_b32 v92, 0
  v_mov_b32 v93, 0
  v_mov_b32 v94, 0
  v_mov_b32 v95, 0
  v_mov_b32 v96, 0
  v_mov_b32 v97, 0
  v_mov_b32 v98, 0
  v_mov_b32 v99, 0
  v_mov_b32 v44, 0
  v_mov_b32 v28, 0
  v_mov_b32 v45, 0
  v_mov_b32 v29, 0
  v_mov_b32 v46, 0
  v_mov_b32 v30, 0
  v_mov_b32 v47, 0
  v_mov_b32 v31, 0
  v_mov_b32 v48, 0
  v_mov_b32 v32, 0
  v_mov_b32 v49, 0
  v_mov_b32 v33, 0
  v_mov_b32 v50, 0
  v_mov_b32 v34, 0
  v_mov_b32 v51, 0
  v_mov_b32 v35, 0
  s_add_u32 s52, s30, 17825792
  s_addc_u32 s53, s31, 0
  s_mov_b32 s54, 8192
  s_mov_b32 s55, 0x00020000
  s_cmp_eq_u32 s20, 0
  s_cbranch_scc0 L_wt_c1
  v_lshlrev_b32 v52, 5, v1
  v_add_u32 v52, s23, v52
  v_mul_u32_u24 v52, 43, v52
  v_lshrrev_b32 v52, 8, v52
  v_lshlrev_b32 v52, 7, v52
  s_movk_i32 s56, 6144
  s_mov_b32 s57, 0
  s_mov_b64 exec, 7
L_spin_c1:
  s_sleep 10
  buffer_load_dword v53, v52, s[52:55], s56 offen sc1
  s_add_u32 s57, s57, 1
  s_waitcnt vmcnt(0)
  v_cmp_gt_u32 vcc, 16, v53
  s_cmp_ge_u32 s57, 40000
  s_cbranch_scc1 L_spun_c1
  s_cmp_eq_u64 vcc, 0
  s_cbranch_scc0 L_spin_c1
L_spun_c1:
  s_mov_b64 exec, -1
L_wt_c1:
  s_barrier
  buffer_load_dwordx4 v[8:11], v4, s[8:11], s28 offen
  s_cmp_eq_u32 s35, 0
  s_cbranch_scc0 L_attn_nodma0
  s_add_u32 m0, s25, 0
  s_add_u32 s38, s26, 0
  buffer_load_dwordx4 v4, s[4:7], s38 offen lds
  s_add_u32 s38, s38, 1024
  s_add_u32 m0, s25, 1024
  buffer_load_dwordx4 v4, s[4:7], s38 offen lds
  s_add_u32 s38, s38, 1024
  s_add_u32 m0, s25, 2048
  buffer_load_dwordx4 v4, s[4:7], s38 offen lds
  s_add_u32 s38, s38, 1024
  s_add_u32 m0, s25, 3072
  buffer_load_dwordx4 v4, s[4:7], s38 offen lds
  s_add_u32 m0, s25, 4096
  s_add_u32 s38, s26, 4096
  buffer_load_dwordx4 v4, s[4:7], s38 offen lds
  s_add_u32 s38, s38, 1024
  s_add_u32 m0, s25, 5120
  buffer_load_dwordx4 v4, s[4:7], s38 offen lds
  s_add_u32 s38, s38, 1024
  s_add_u32 m0, s25, 6144
  buffer_load_dwordx4 v4, s[4:7], s38 offen lds
  s_add_u32 s38, s38, 1024
  s_add_u32 m0, s25, 7168
  buffer_load_dwordx4 v4, s[4:7], s38 offen lds
L_attn_nodma0:
  s_waitcnt vmcnt(0) lgkmcnt(0)
  s_barrier
  s_cmp_eq_u32 s35, 0
  s_cbranch_scc1 L_attn_nodma1
  s_add_u32 m0, s25, 0
  s_add_u32 s38, s26, 0
  buffer_load_dwordx4 v4, s[4:7], s38 offen lds
  s_add_u32 s38, s38, 1024
  s_add_u32 m0, s25, 1024
  buffer_load_dwordx4 v4, s[4:7], s38 offen lds
  s_add_u32 s38, s38, 1024
  s_add_u32 m0, s25, 2048
  buffer_load_dwordx4 v4, s[4:7], s38 offen lds
  s_add_u32 s38, s38, 1024
  s_add_u32 m0, s25, 3072
  buffer_load_dwordx4 v4, s[4:7], s38 offen lds
  s_add_u32 m0, s25, 4096
  s_add_u32 s38, s26, 4096
  buffer_load_dwordx4 v4, s[4:7], s38 offen lds
  s_add_u32 s38, s38, 1024
  s_add_u32 m0, s25, 5120
  buffer_load_dwordx4 v4, s[4:7], s38 offen lds
  s_add_u32 s38, s38, 1024
  s_add_u32 m0, s25, 6144
  buffer_load_dwordx4 v4, s[4:7], s38 offen lds
  s_add_u32 s38, s38, 1024
  s_add_u32 m0, s25, 7168
  buffer_load_dwordx4 v4, s[4:7], s38 offen lds
L_attn_nodma1:
  ds_read_b128 v[12:15], v2
  ds_read_b128 v[16:19], v2 offset:1024
  s_waitcnt lgkmcnt(1)
  v_mfma_f32_32x32x16_bf16 v[52:67], v[12:15], v[8:11], 0
  s_nop 7
  s_mov_b32 s32, 0
  s_setprio 3
L_attn_loop:
  s_cmp_eq_u32 s32, 1
  s_cbranch_scc0 L_attn_nosync
  s_waitcnt vmcnt(0)
  s_barrier
L_attn_nosync:
  s_cmp_eq_u32 s32, 0
  s_cbranch_scc1 L_attn_nopf
  s_cmp_eq_u32 s32, 2
  s_cselect_b32 s40, s46, s40
  s_cselect_b32 s41, s47, s41
  s_cselect_b32 s42, 1409024, s42
  s_cselect_b32 s50, s51, s50
  s_cmp_eq_u32 s32, 5
  s_cselect_b32 s40, s48, s40
  s_cselect_b32 s41, s49, s41
  s_cselect_b32 s50, s51, s50
  buffer_load_dwordx4 v[124:127], v4, s[40:43], s50 offen
  s_add_u32 s50, s50, 0x80000
L_attn_nopf:
  s_cmp_eq_u32 s32, 6
  s_cbranch_scc0 L_attn_p_24
  s_setprio 2
L_attn_p_24:
  s_cmp_eq_u32 s32, 7
  s_cbranch_scc0 L_attn_p_28
  s_setprio 1
L_attn_p_28:
  s_waitcnt lgkmcnt(0)
  v_mfma_f32_32x32x16_bf16 v[68:83], v[16:19], v[8:11], 0
  ds_read_b128 v[12:15], v2 offset:2048
  ds_read_b64_tr_b16 v[20:21], v3 offset:0
  ds_read_b64_tr_b16 v[22:23], v3 offset:256
  ds_read_b64_tr_b16 v[24:25], v3 offset:512
  ds_read_b64_tr_b16 v[26:27], v3 offset:768
  v_exp_f32 v52, v52
  v_exp_f32 v53, v53
  v_exp_f32 v54, v54
  v_exp_f32 v55, v55
  v_cvt_pk_bf16_f32 v36, v52, v53
  v_exp_f32 v56, v56
  v_exp_f32 v57, v57
  v_cvt_pk_bf16_f32 v37, v54, v55
  v_mfma_f32_32x32x16_bf16 v[84:99], v[28:31], v[44:47], v[84:99]
  v_exp_f32 v58, v58
  v_exp_f32 v59, v59
  v_cvt_pk_bf16_f32 v38, v56, v57
  v_exp_f32 v60, v60
  v_exp_f32 v61, v61
  v_cvt_pk_bf16_f32 v39, v58, v59
  v_exp_f32 v62, v62
  v_exp_f32 v63, v63
  v_cvt_pk_bf16_f32 v40, v60, v61
  v_mfma_f32_32x32x16_bf16 v[84:99], v[32:35], v[48:51], v[84:99]
  v_exp_f32 v64, v64
  v_exp_f32 v65, v65
  v_cvt_pk_bf16_f32 v41, v62, v63
  v_exp_f32 v66, v66
  v_exp_f32 v67, v67
  v_cvt_pk_bf16_f32 v42, v64, v65
  s_nop 0
  v_cvt_pk_bf16_f32 v43, v66, v67
  s_waitcnt lgkmcnt(0)
  v_mfma_f32_32x32x16_bf16 v[52:67], v[12:15], v[8:11], 0
  ds_read_b128 v[16:19], v2 offset:3072
  ds_read_b64_tr_b16 v[28:29], v3 offset:1024
  ds_read_b64_tr_b16 v[30:31], v3 offset:1280
  ds_read_b64_tr_b16 v[32:33], v3 offset:1536
  ds_read_b64_tr_b16 v[34:35], v3 offset:1792
  v_exp_f32 v68, v68
  v_exp_f32 v69, v69
  v_exp_f32 v70, v70
  v_exp_f32 v71, v71
  v_cvt_pk_bf16_f32 v44, v68, v69
  v_exp_f32 v72, v72
  v_exp_f32 v73, v73
  v_cvt_pk_bf16_f32 v45, v70, v71
  v_mfma_f32_32x32x16_bf16 v[84:99], v[20:23], v[36:39], v[84:99]
  v_exp_f32 v74, v74
  v_exp_f32 v75, v75
  v_cvt_pk_bf16_f32 v46, v72, v73
  v_exp_f32 v76, v76
  v_exp_f32 v77, v77
  v_cvt_pk_bf16_f32 v47, v74, v75
  v_exp_f32 v78, v78
  v_exp_f32 v79, v79
  v_cvt_pk_bf16_f32 v48, v76, v77
  v_mfma_f32_32x32x16_bf16 v[84:99], v[24:27], v[40:43], v[84:99]
  v_exp_f32 v80, v80
  v_exp_f32 v81, v81
  v_cvt_pk_bf16_f32 v49, v78, v79
  v_exp_f32 v82, v82
  v_exp_f32 v83, v83
  v_cvt_pk_bf16_f32 v50, v80, v81
  s_nop 0
  v_cvt_pk_bf16_f32 v51, v82, v83
  s_waitcnt lgkmcnt(0)
  v_mfma_f32_32x32x16_bf16 v[68:83], v[16:19], v[8:11], 0
  ds_read_b128 v[12:15], v2 offset:4096
  ds_read_b64_tr_b16 v[20:21], v3 offset:2048
  ds_read_b64_tr_b16 v[22:23], v3 offset:2304
  ds_read_b64_tr_b16 v[24:25], v3 offset:2560
  ds_read_b64_tr_b16 v[26:27], v3 offset:2816
  v_exp_f32 v52, v52
  v_exp_f32 v53, v53
  v_exp_f32 v54, v54
  v_exp_f32 v55, v55
  v_cvt_pk_bf16_f32 v36, v52, v53
  v_exp_f32 v56, v56
  v_exp_f32 v57, v57
  v_cvt_pk_bf16_f32 v37, v54, v55
  v_mfma_f32_32x32x16_bf16 v[84:99], v[28:31], v[44:47], v[84:99]
  v_exp_f32 v58, v58
  v_exp_f32 v59, v59
  v_cvt_pk_bf16_f32 v38, v56, v57
  v_exp_f32 v60, v60
  v_exp_f32 v61, v61
  v_cvt_pk_bf16_f32 v39, v58, v59
  v_exp_f32 v62, v62
  v_exp_f32 v63, v63
  v_cvt_pk_bf16_f32 v40, v60, v61
  v_mfma_f32_32x32x16_bf16 v[84:99], v[32:35], v[48:51], v[84:99]
  v_exp_f32 v64, v64
  v_exp_f32 v65, v65
  v_cvt_pk_bf16_f32 v41, v62, v63
  v_exp_f32 v66, v66
  v_exp_f32 v67, v67
  v_cvt_pk_bf16_f32 v42, v64, v65
  s_nop 0
  v_cvt_pk_bf16_f32 v43, v66, v67
  s_cmp_eq_u32 s32, 7
  s_cbranch_scc0 L_attn_p_31
  s_setprio 0
L_attn_p_31:
  s_waitcnt lgkmcnt(0)
  v_mfma_f32_32x32x16_bf16 v[52:67], v[12:15], v[8:11], 0
  ds_read_b128 v[16:19], v2 offset:5120
  ds_read_b64_tr_b16 v[28:29], v3 offset:3072
  ds_read_b64_tr_b16 v[30:31], v3 offset:3328
  ds_read_b64_tr_b16 v[32:33], v3 offset:3584
  ds_read_b64_tr_b16 v[34:35], v3 offset:3840
  v_exp_f32 v68, v68
  v_exp_f32 v69, v69
  v_exp_f32 v70, v70
  v_exp_f32 v71, v71
  v_cvt_pk_bf16_f32 v44, v68, v69
  v_exp_f32 v72, v72
  v_exp_f32 v73, v73
  v_cvt_pk_bf16_f32 v45, v70, v71
  v_mfma_f32_32x32x16_bf16 v[84:99], v[20:23], v[36:39], v[84:99]
  v_exp_f32 v74, v74
  v_exp_f32 v75, v75
  v_cvt_pk_bf16_f32 v46, v72, v73
  v_exp_f32 v76, v76
  v_exp_f32 v77, v77
  v_cvt_pk_bf16_f32 v47, v74, v75
  v_exp_f32 v78, v78
  v_exp_f32 v79, v79
  v_cvt_pk_bf16_f32 v48, v76, v77
  v_mfma_f32_32x32x16_bf16 v[84:99], v[24:27], v[40:43], v[84:99]
  v_exp_f32 v80, v80
  v_exp_f32 v81, v81
  v_cvt_pk_bf16_f32 v49, v78, v79
  v_exp_f32 v82, v82
  v_exp_f32 v83, v83
  v_cvt_pk_bf16_f32 v50, v80, v81
  s_nop 0
  v_cvt_pk_bf16_f32 v51, v82, v83
  v_add_u32 v2, 4096, v2
  v_add_u32 v3, v3, v7
  s_add_u32 s32, s32, 1
  s_cmp_lt_u32 s32, 8
  s_cbranch_scc1 L_attn_loop
  s_waitcnt lgkmcnt(0)
  v_mfma_f32_32x32x16_bf16 v[84:99], v[28:31], v[44:47], v[84:99]
  v_mfma_f32_32x32x16_bf16 v[84:99], v[32:35], v[48:51], v[84:99]
  s_nop 15
  s_nop 3
  v_mul_f32 v117, 0, v84
  v_mul_f32 v118, 0, v85
  s_mov_b32 s34, 0x5f800000
  v_cmp_nle_f32 s[36:37], v92, s34
  s_mov_b32 s34, 0x21800000
  v_cmp_nge_f32 s[38:39], v92, s34
  v_fma_f32 v117, v86, 0, v117
  v_fma_f32 v118, v87, 0, v118
  v_fma_f32 v117, v88, 0, v117
  v_fma_f32 v118, v89, 0, v118
  v_fma_f32 v117, v90, 0, v117
  v_fma_f32 v118, v91, 0, v118
  v_add_f32 v117, v117, v118
  s_or_b64 s[36:37], s[36:37], s[38:39]
  v_cmp_u_f32 vcc, v117, v117
  s_or_b64 s[36:37], s[36:37], vcc
  s_cmp_eq_u64 s[36:37], 0
  s_cbranch_scc1 L_attn_done
  s_waitcnt vmcnt(0)
  v_mov_b32 v2, v6
  v_mov_b32 v116, 0xff800000
  s_mov_b32 s32, 0
L_attn_maxloop:
  ds_read_b128 v[12:15], v2
  s_waitcnt lgkmcnt(0)
  v_mfma_f32_32x32x16_bf16 v[52:67], v[12:15], v[8:11], 0
  s_nop 15
  s_nop 3
  v_max3_f32 v116, v116, v52, v53
  v_max3_f32 v116, v116, v54, v55
  v_max3_f32 v116, v116, v56, v57
  v_max3_f32 v116, v116, v58, v59
  v_max3_f32 v116, v116, v60, v61
  v_max3_f32 v116, v116, v62, v63
  v_max3_f32 v116, v116, v64, v65
  v_max3_f32 v116, v116, v66, v67
  v_add_u32 v2, 1024, v2
  s_add_u32 s32, s32, 1
  s_cmp_lt_u32 s32, 32
  s_cbranch_scc1 L_attn_maxloop
  v_mov_b32 v117, v116
  s_nop 1
  v_permlane32_swap_b32 v116, v117
  s_nop 1
  v_max_f32 v116, v116, v117
  v_sub_f32 v100, 0, v116
  v_sub_f32 v101, 0, v116
  v_sub_f32 v102, 0, v116
  v_sub_f32 v103, 0, v116
  v_sub_f32 v104, 0, v116
  v_sub_f32 v105, 0, v116
  v_sub_f32 v106, 0, v116
  v_sub_f32 v107, 0, v116
  v_sub_f32 v108, 0, v116
  v_sub_f32 v109, 0, v116
  v_sub_f32 v110, 0, v116
  v_sub_f32 v111, 0, v116
  v_sub_f32 v112, 0, v116
  v_sub_f32 v113, 0, v116
  v_sub_f32 v114, 0, v116
  v_sub_f32 v115, 0, v116
  v_mov_b32 v84, 0
  v_mov_b32 v85, 0
  v_mov_b32 v86, 0
  v_mov_b32 v87, 0
  v_mov_b32 v88, 0
  v_mov_b32 v89, 0
  v_mov_b32 v90, 0
  v_mov_b32 v91, 0
  v_mov_b32 v92, 0
  v_mov_b32 v93, 0
  v_mov_b32 v94, 0
  v_mov_b32 v95, 0
  v_mov_b32 v96, 0
  v_mov_b32 v97, 0
  v_mov_b32 v98, 0
  v_mov_b32 v99, 0
  v_mov_b32 v44, 0
  v_mov_b32 v28, 0
  v_mov_b32 v45, 0
  v_mov_b32 v29, 0
  v_mov_b32 v46, 0
  v_mov_b32 v30, 0
  v_mov_b32 v47, 0
  v_mov_b32 v31, 0
  v_mov_b32 v48, 0
  v_mov_b32 v32, 0
  v_mov_b32 v49, 0
  v_mov_b32 v33, 0
  v_mov_b32 v50, 0
  v_mov_b32 v34, 0
  v_mov_b32 v51, 0
  v_mov_b32 v35, 0
  v_mov_b32 v2, v6
  v_mov_b32 v3, v5
  ds_read_b128 v[12:15], v2
  ds_read_b128 v[16:19], v2 offset:1024
  s_waitcnt lgkmcnt(1)
  v_mfma_f32_32x32x16_bf16 v[52:67], v[12:15], v[8:11], v[100:115]
  s_nop 7
  s_mov_b32 s32, 0
  s_setprio 3
L_attn_loop2:
  s_cmp_eq_u32 s32, 6
  s_cbranch_scc0 L_attn_p2_24
  s_setprio 2
L_attn_p2_24:
  s_cmp_eq_u32 s32, 7
  s_cbranch_scc0 L_attn_p2_28
  s_setprio 1
L_attn_p2_28:
  s_waitcnt lgkmcnt(0)
  v_mfma_f32_32x32x16_bf16 v[68:83], v[16:19], v[8:11], v[100:115]
  ds_read_b128 v[12:15], v2 offset:2048
  ds_read_b64_tr_b16 v[20:21], v3 offset:0
  ds_read_b64_tr_b16 v[22:23], v3 offset:256
  ds_read_b64_tr_b16 v[24:25], v3 offset:512
  ds_read_b64_tr_b16 v[26:27], v3 offset:768
  v_exp_f32 v52, v52
  v_exp_f32 v53, v53
  v_exp_f32 v54, v54
  v_exp_f32 v55, v55
  v_cvt_pk_bf16_f32 v36, v52, v53
  v_exp_f32 v56, v56
  v_exp_f32 v57, v57
  v_cvt_pk_bf16_f32 v37, v54, v55
  v_mfma_f32_32x32x16_bf16 v[84:99], v[28:31], v[44:47], v[84:99]
  v_exp_f32 v58, v58
  v_exp_f32 v59, v59
  v_cvt_pk_bf16_f32 v38, v56, v57
  v_exp_f32 v60, v60
  v_exp_f32 v61, v61
  v_cvt_pk_bf16_f32 v39, v58, v59
  v_exp_f32 v62, v62
  v_exp_f32 v63, v63
  v_cvt_pk_bf16_f32 v40, v60, v61
  v_mfma_f32_32x32x16_bf16 v[84:99], v[32:35], v[48:51], v[84:99]
  v_exp_f32 v64, v64
  v_exp_f32 v65, v65
  v_cvt_pk_bf16_f32 v41, v62, v63
  v_exp_f32 v66, v66
  v_exp_f32 v67, v67
  v_cvt_pk_bf16_f32 v42, v64, v65
  s_nop 0
  v_cvt_pk_bf16_f32 v43, v66, v67
  s_waitcnt lgkmcnt(0)
  v_mfma_f32_32x32x16_bf16 v[52:67], v[12:15], v[8:11], v[100:115]
  ds_read_b128 v[16:19], v2 offset:3072
  ds_read_b64_tr_b16 v[28:29], v3 offset:1024
  ds_read_b64_tr_b16 v[30:31], v3 offset:1280
  ds_read_b64_tr_b16 v[32:33], v3 offset:1536
  ds_read_b64_tr_b16 v[34:35], v3 offset:1792
  v_exp_f32 v68, v68
  v_exp_f32 v69, v69
  v_exp_f32 v70, v70
  v_exp_f32 v71, v71
  v_cvt_pk_bf16_f32 v44, v68, v69
  v_exp_f32 v72, v72
  v_exp_f32 v73, v73
  v_cvt_pk_bf16_f32 v45, v70, v71
  v_mfma_f32_32x32x16_bf16 v[84:99], v[20:23], v[36:39], v[84:99]
  v_exp_f32 v74, v74
  v_exp_f32 v75, v75
  v_cvt_pk_bf16_f32 v46, v72, v73
  v_exp_f32 v76, v76
  v_exp_f32 v77, v77
  v_cvt_pk_bf16_f32 v47, v74, v75
  v_exp_f32 v78, v78
  v_exp_f32 v79, v79
  v_cvt_pk_bf16_f32 v48, v76, v77
  v_mfma_f32_32x32x16_bf16 v[84:99], v[24:27], v[40:43], v[84:99]
  v_exp_f32 v80, v80
  v_exp_f32 v81, v81
  v_cvt_pk_bf16_f32 v49, v78, v79
  v_exp_f32 v82, v82
  v_exp_f32 v83, v83
  v_cvt_pk_bf16_f32 v50, v80, v81
  s_nop 0
  v_cvt_pk_bf16_f32 v51, v82, v83
  s_waitcnt lgkmcnt(0)
  v_mfma_f32_32x32x16_bf16 v[68:83], v[16:19], v[8:11], v[100:115]
  ds_read_b128 v[12:15], v2 offset:4096
  ds_read_b64_tr_b16 v[20:21], v3 offset:2048
  ds_read_b64_tr_b16 v[22:23], v3 offset:2304
  ds_read_b64_tr_b16 v[24:25], v3 offset:2560
  ds_read_b64_tr_b16 v[26:27], v3 offset:2816
  v_exp_f32 v52, v52
  v_exp_f32 v53, v53
  v_exp_f32 v54, v54
  v_exp_f32 v55, v55
  v_cvt_pk_bf16_f32 v36, v52, v53
  v_exp_f32 v56, v56
  v_exp_f32 v57, v57
  v_cvt_pk_bf16_f32 v37, v54, v55
  v_mfma_f32_32x32x16_bf16 v[84:99], v[28:31], v[44:47], v[84:99]
  v_exp_f32 v58, v58
  v_exp_f32 v59, v59
  v_cvt_pk_bf16_f32 v38, v56, v57
  v_exp_f32 v60, v60
  v_exp_f32 v61, v61
  v_cvt_pk_bf16_f32 v39, v58, v59
  v_exp_f32 v62, v62
  v_exp_f32 v63, v63
  v_cvt_pk_bf16_f32 v40, v60, v61
  v_mfma_f32_32x32x16_bf16 v[84:99], v[32:35], v[48:51], v[84:99]
  v_exp_f32 v64, v64
  v_exp_f32 v65, v65
  v_cvt_pk_bf16_f32 v41, v62, v63
  v_exp_f32 v66, v66
  v_exp_f32 v67, v67
  v_cvt_pk_bf16_f32 v42, v64, v65
  s_nop 0
  v_cvt_pk_bf16_f32 v43, v66, v67
  s_cmp_eq_u32 s32, 7
  s_cbranch_scc0 L_attn_p2_31
  s_setprio 0
L_attn_p2_31:
  s_waitcnt lgkmcnt(0)
  v_mfma_f32_32x32x16_bf16 v[52:67], v[12:15], v[8:11], v[100:115]
  ds_read_b128 v[16:19], v2 offset:5120
  ds_read_b64_tr_b16 v[28:29], v3 offset:3072
  ds_read_b64_tr_b16 v[30:31], v3 offset:3328
  ds_read_b64_tr_b16 v[32:33], v3 offset:3584
  ds_read_b64_tr_b16 v[34:35], v3 offset:3840
  v_exp_f32 v68, v68
  v_exp_f32 v69, v69
  v_exp_f32 v70, v70
  v_exp_f32 v71, v71
  v_cvt_pk_bf16_f32 v44, v68, v69
  v_exp_f32 v72, v72
  v_exp_f32 v73, v73
  v_cvt_pk_bf16_f32 v45, v70, v71
  v_mfma_f32_32x32x16_bf16 v[84:99], v[20:23], v[36:39], v[84:99]
  v_exp_f32 v74, v74
  v_exp_f32 v75, v75
  v_cvt_pk_bf16_f32 v46, v72, v73
  v_exp_f32 v76, v76
  v_exp_f32 v77, v77
  v_cvt_pk_bf16_f32 v47, v74, v75
  v_exp_f32 v78, v78
  v_exp_f32 v79, v79
  v_cvt_pk_bf16_f32 v48, v76, v77
  v_mfma_f32_32x32x16_bf16 v[84:99], v[24:27], v[40:43], v[84:99]
  v_exp_f32 v80, v80
  v_exp_f32 v81, v81
  v_cvt_pk_bf16_f32 v49, v78, v79
  v_exp_f32 v82, v82
  v_exp_f32 v83, v83
  v_cvt_pk_bf16_f32 v50, v80, v81
  s_nop 0
  v_cvt_pk_bf16_f32 v51, v82, v83
  v_add_u32 v2, 4096, v2
  v_add_u32 v3, v3, v7
  s_add_u32 s32, s32, 1
  s_cmp_lt_u32 s32, 8
  s_cbranch_scc1 L_attn_loop2
  s_waitcnt lgkmcnt(0)
  v_mfma_f32_32x32x16_bf16 v[84:99], v[28:31], v[44:47], v[84:99]
  v_mfma_f32_32x32x16_bf16 v[84:99], v[32:35], v[48:51], v[84:99]
  s_nop 15
  s_nop 3
L_attn_done:
  s_mul_i32 s38, s21, 2560
  s_add_u32 s38, s38, 135680
  v_add_u32 v2, s38, v4
  v_lshlrev_b32 v3, 3, v1
  v_add_u32 v3, s38, v3
  v_mov_b32 v93, v116
  s_lshl_b32 s38, s27, 5
  s_add_u32 s38, s38, s23
  s_lshl_b32 s38, s38, 10
  s_mov_b32 s33, s22
  s_cmp_eq_u32 s22, 0
  s_cselect_b64 exec, 0, -1
  ds_write_b128 v2, v[84:87]
  ds_write_b128 v2, v[88:91] offset:1024
  ds_write_b64 v3, v[92:93] offset:2048
  s_waitcnt lgkmcnt(0)
  s_cbranch_scc1 L_attn_comb
  s_barrier
  s_branch L_attn_fin
L_attn_comb:
  ds_read_b64 v[60:61], v3 offset:2048
  ds_read_b128 v[52:55], v2
  ds_read_b128 v[56:59], v2 offset:1024
  s_waitcnt lgkmcnt(2)
  v_max_f32 v117, v116, v61
  v_sub_f32 v118, v116, v117
  v_sub_f32 v119, v61, v117
  v_exp_f32 v118, v118
  v_exp_f32 v119, v119
  s_nop 0
  v_mul_f32 v92, v92, v118
  v_fma_f32 v92, v60, v119, v92
  v_rcp_f32 v120, v92
  s_nop 0
  v_mul_f32 v118, v118, v120
  v_mul_f32 v119, v119, v120
  v_mul_f32 v84, v84, v118
  v_mul_f32 v85, v85, v118
  v_mul_f32 v86, v86, v118
  v_mul_f32 v87, v87, v118
  v_mul_f32 v88, v88, v118
  v_mul_f32 v89, v89, v118
  v_mul_f32 v90, v90, v118
  v_mul_f32 v91, v91, v118
  s_waitcnt lgkmcnt(0)
  v_fma_f32 v84, v52, v119, v84
  v_fma_f32 v85, v53, v119, v85
  v_fma_f32 v86, v54, v119, v86
  v_fma_f32 v87, v55, v119, v87
  v_fma_f32 v88, v56, v119, v88
  v_fma_f32 v89, v57, v119, v89
  v_fma_f32 v90, v58, v119, v90
  v_fma_f32 v91, v59, v119, v91
  v_cvt_pk_bf16_f32 v36, v84, v85
  v_cvt_pk_bf16_f32 v37, v86, v87
  v_cvt_pk_bf16_f32 v38, v88, v89
  v_cvt_pk_bf16_f32 v39, v90, v91
  buffer_store_dwordx4 v[36:39], v4, s[12:15], s38 offen sc1
  s_cmp_eq_u32 s33, 2
  s_cbranch_scc1 L_attn_fin
  s_mov_b32 s33, 2
  s_mov_b64 exec, -1
  s_barrier
  s_branch L_attn_comb
L_attn_fin:
  s_cmp_eq_u32 s22, 0
  s_cbranch_scc1 L_attn_cont
  s_endpgm
L_attn_cont:
  s_add_u32 s52, s30, 17825792
  s_addc_u32 s53, s31, 0
  s_mov_b32 s54, 8192
  s_mov_b32 s55, 0x00020000
  s_waitcnt vmcnt(0)
  s_barrier
  s_cmp_eq_u32 s20, 0
  s_cbranch_scc0 L_sig_c2
  s_lshl_b32 s56, s24, 7
  s_add_u32 s56, s56, 4096
  v_mov_b32 v5, 0
  v_mov_b32 v6, 1
  s_mov_b64 exec, 1
  buffer_atomic_add v6, v5, s[52:55], s56 offen sc1
  s_mov_b64 exec, -1
L_sig_c2:
  s_load_dwordx2 s[30:31], s[0:1], 72
  s_load_dwordx2 s[32:33], s[0:1], 16
  s_load_dwordx2 s[34:35], s[0:1], 0
  s_and_b32 s3, s2, 7
  s_lshr_b32 s38, s2, 3
  s_lshl_b32 s23, s3, 2
  s_and_b32 s39, s38, 3
  s_add_u32 s23, s23, s39
  s_lshr_b32 s24, s38, 2
  v_and_b32 v1, 63, v0
  v_lshrrev_b32 v2, 6, v0
  s_nop 0
  v_readfirstlane_b32 s20, v2
  s_nop 3
  s_and_b32 s21, s20, 1
  s_lshr_b32 s22, s20, 2
  s_lshr_b32 s25, s20, 1
  s_and_b32 s25, s25, 1
  v_and_b32 v2, 31, v1
  v_lshrrev_b32 v3, 5, v1
  s_lshl_b32 s38, s23, 1
  s_mul_i32 s38, s38, 32
  s_add_u32 s38, s38, s20
  s_lshl_b32 s38, s38, 10
  v_lshlrev_b32 v4, 4, v1
  v_add_u32 v10, s38, v4
  v_add_u32 v11, 32768, v10
  v_lshrrev_b32 v5, 3, v1
  s_lshl_b32 s38, s20, 4
  v_add_u32 v5, s38, v5
  v_lshlrev_b32 v5, 10, v5
  v_lshrrev_b32 v6, 4, v1
  v_and_b32 v6, 1, v6
  v_lshlrev_b32 v6, 2, v6
  v_and_b32 v7, 7, v1
  v_xor_b32 v6, v6, v7
  v_lshlrev_b32 v6, 4, v6
  v_add_u32 v5, v5, v6
  s_lshl_b32 s38, s24, 7
  v_add_u32 v12, s38, v5
  s_lshl_b32 s40, s23, 1
  s_add_u32 s40, s40, s21
  s_lshl_b32 s41, s24, 2
  s_lshl_b32 s38, s25, 1
  s_add_u32 s41, s41, s38
  s_add_u32 s41, s41, s22
  s_lshl_b32 s42, s40, 5
  s_add_u32 s42, s42, s41
  s_lshl_b32 s42, s42, 10
  s_lshl_b32 s43, s40, 15
  s_lshl_b32 s38, s41, 5
  s_add_u32 s43, s43, s38
  v_lshlrev_b32 v8, 10, v2
  s_waitcnt lgkmcnt(0)
  s_add_u32 s4, s30, 6291456
  s_addc_u32 s5, s31, 0
  s_mov_b32 s6, 2097152
  s_mov_b32 s7, 0x00020000
  s_add_u32 s12, s30, 8388608
  s_addc_u32 s13, s31, 0
  s_mov_b32 s14, 2097152
  s_mov_b32 s15, 0x00020000
  s_mov_b32 s16, s34
  s_mov_b32 s17, s35
  s_mov_b32 s18, 2097152
  s_mov_b32 s19, 0x00020000
  s_mov_b32 s8, s32
  s_mov_b32 s9, s33
  s_mov_b32 s10, 524288
  s_mov_b32 s11, 0x00020000
  v_lshlrev_b32 v13, 4, v3
  v_add_u32 v13, v13, v8
  s_lshl_b32 s26, s20, 11
  s_add_u32 s52, s30, 17825792
  s_addc_u32 s53, s31, 0
  s_mov_b32 s54, 8192
  s_mov_b32 s55, 0x00020000
  s_add_u32 m0, s26, 16384
  s_mov_b32 s38, 0
  buffer_load_dwordx4 v12, s[8:11], s38 offen lds
  s_add_u32 m0, s26, 17408
  s_mov_b32 s38, 8192
  buffer_load_dwordx4 v12, s[8:11], s38 offen lds
  s_add_u32 m0, s26, 49152
  s_mov_b32 s38, 131072
  buffer_load_dwordx4 v12, s[8:11], s38 offen lds
  s_add_u32 m0, s26, 50176
  s_mov_b32 s38, 139264
  buffer_load_dwordx4 v12, s[8:11], s38 offen lds
  s_add_u32 m0, s26, 81920
  s_mov_b32 s38, 262144
  buffer_load_dwordx4 v12, s[8:11], s38 offen lds
  s_add_u32 m0, s26, 82944
  s_mov_b32 s38, 270336
  buffer_load_dwordx4 v12, s[8:11], s38 offen lds
  s_add_u32 m0, s26, 114688
  s_mov_b32 s38, 393216
  buffer_load_dwordx4 v12, s[8:11], s38 offen lds
  s_add_u32 m0, s26, 115712
  s_mov_b32 s38, 401408
  buffer_load_dwordx4 v12, s[8:11], s38 offen lds
  s_lshr_b32 s39, s23, 2
  s_cmp_eq_u32 s20, 0
  s_cbranch_scc0 L_wt_c2
  s_lshl_b32 s56, s39, 7
  s_add_u32 s56, s56, 4096
  v_mov_b32 v5, 0
  s_mov_b32 s57, 0
L_spin_c2:
  s_sleep 10
  buffer_load_dword v6, v5, s[52:55], s56 offen sc1
  s_add_u32 s57, s57, 1
  s_waitcnt vmcnt(0)
  v_readfirstlane_b32 s38, v6
  s_cmp_ge_u32 s57, 40000
  s_cbranch_scc1 L_wt_c2
  s_cmp_lt_u32 s38, 32
  s_cbranch_scc1 L_spin_c2
L_wt_c2:
  s_barrier
  s_add_u32 m0, s26, 0
  s_movk_i32 s38, 0
  buffer_load_dwordx4 v10, s[4:7], s38 offen lds
  s_add_u32 m0, s26, 1024
  s_movk_i32 s38, 0
  buffer_load_dwordx4 v11, s[4:7], s38 offen lds
  s_add_u32 m0, s26, 32768
  s_movk_i32 s38, 8192
  buffer_load_dwordx4 v10, s[4:7], s38 offen lds
  s_add_u32 m0, s26, 33792
  s_movk_i32 s38, 8192
  buffer_load_dwordx4 v11, s[4:7], s38 offen lds
  s_add_u32 m0, s26, 65536
  s_movk_i32 s38, 16384
  buffer_load_dwordx4 v10, s[4:7], s38 offen lds
  s_add_u32 m0, s26, 66560
  s_movk_i32 s38, 16384
  buffer_load_dwordx4 v11, s[4:7], s38 offen lds
  s_add_u32 m0, s26, 98304
  s_movk_i32 s38, 24576
  buffer_load_dwordx4 v10, s[4:7], s38 offen lds
  s_add_u32 m0, s26, 99328
  s_movk_i32 s38, 24576
  buffer_load_dwordx4 v11, s[4:7], s38 offen lds
  s_lshl_b32 s38, s22, 13
  s_lshl_b32 s39, s21, 10
  s_add_u32 s38, s38, s39
  v_add_u32 v17, s38, v4
  v_and_b32 v5, 15, v1
  v_lshrrev_b32 v6, 2, v5
  v_lshlrev_b32 v7, 3, v3
  v_add_u32 v6, v6, v7
  s_lshl_b32 s38, s22, 6
  v_add_u32 v6, s38, v6
  v_lshlrev_b32 v6, 7, v6
  v_lshrrev_b32 v7, 4, v1
  v_and_b32 v7, 1, v7
  v_xor_b32 v7, s22, v7
  v_lshlrev_b32 v7, 1, v7
  v_bfe_u32 v9, v5, 1, 1
  v_add_u32 v7, v7, v9
  s_lshl_b32 s38, s25, 2
  v_add_u32 v7, s38, v7
  v_lshrrev_b32 v9, 3, v5
  v_lshlrev_b32 v9, 2, v9
  v_xor_b32 v7, v7, v9
  v_lshlrev_b32 v7, 4, v7
  v_add_u32 v6, v6, v7
  v_and_b32 v7, 1, v5
  v_lshlrev_b32 v7, 3, v7
  v_add_u32 v6, v6, v7
  v_add_u32 v21, 16384, v6
  v_add_u32 v18, 0x10000, v17
  v_add_u32 v22, 0x10000, v21
  v_add_u32 v19, 0x20000, v17
  v_add_u32 v23, 0x20000, v21
  v_mov_b32 v48, 0
  v_mov_b32 v49, 0
  v_mov_b32 v50, 0
  v_mov_b32 v51, 0
  v_mov_b32 v52, 0
  v_mov_b32 v53, 0
  v_mov_b32 v54, 0
  v_mov_b32 v55, 0
  v_mov_b32 v56, 0
  v_mov_b32 v57, 0
  v_mov_b32 v58, 0
  v_mov_b32 v59, 0
  v_mov_b32 v60, 0
  v_mov_b32 v61, 0
  v_mov_b32 v62, 0
  v_mov_b32 v63, 0
  s_waitcnt vmcnt(6)
  s_barrier
  ds_read_b128 v[32:35], v17 offset:0
  ds_read_b64_tr_b16 v[40:41], v21 offset:0
  ds_read_b64_tr_b16 v[42:43], v21 offset:512
  ds_read_b128 v[36:39], v17 offset:2048
  ds_read_b64_tr_b16 v[44:45], v21 offset:2048
  ds_read_b64_tr_b16 v[46:47], v21 offset:2560
  s_waitcnt lgkmcnt(3)
  v_mfma_f32_32x32x16_bf16 v[48:63], v[40:43], v[32:35], v[48:63]
  ds_read_b128 v[32:35], v17 offset:4096
  ds_read_b64_tr_b16 v[40:41], v21 offset:4096
  ds_read_b64_tr_b16 v[42:43], v21 offset:4608
  s_waitcnt lgkmcnt(3)
  v_mfma_f32_32x32x16_bf16 v[48:63], v[44:47], v[36:39], v[48:63]
  ds_read_b128 v[36:39], v17 offset:6144
  ds_read_b64_tr_b16 v[44:45], v21 offset:6144
  ds_read_b64_tr_b16 v[46:47], v21 offset:6656
  s_waitcnt lgkmcnt(3)
  v_mfma_f32_32x32x16_bf16 v[48:63], v[40:43], v[32:35], v[48:63]
  s_waitcnt lgkmcnt(0)
  v_mfma_f32_32x32x16_bf16 v[48:63], v[44:47], v[36:39], v[48:63]
  buffer_load_dwordx4 v[28:31], v13, s[16:19], s43 offen
  s_waitcnt vmcnt(5)
  s_barrier
  ds_read_b128 v[32:35], v17 offset:32768
  ds_read_b64_tr_b16 v[40:41], v21 offset:32768
  ds_read_b64_tr_b16 v[42:43], v21 offset:33280
  ds_read_b128 v[36:39], v17 offset:34816
  ds_read_b64_tr_b16 v[44:45], v21 offset:34816
  ds_read_b64_tr_b16 v[46:47], v21 offset:35328
  s_waitcnt lgkmcnt(3)
  v_mfma_f32_32x32x16_bf16 v[48:63], v[40:43], v[32:35], v[48:63]
  ds_read_b128 v[32:35], v17 offset:36864
  ds_read_b64_tr_b16 v[40:41], v21 offset:36864
  ds_read_b64_tr_b16 v[42:43], v21 offset:37376
  s_waitcnt lgkmcnt(3)
  v_mfma_f32_32x32x16_bf16 v[48:63], v[44:47], v[36:39], v[48:63]
  ds_read_b128 v[36:39], v17 offset:38912
  ds_read_b64_tr_b16 v[44:45], v21 offset:38912
  ds_read_b64_tr_b16 v[46:47], v21 offset:39424
  s_waitcnt lgkmcnt(3)
  v_mfma_f32_32x32x16_bf16 v[48:63], v[40:43], v[32:35], v[48:63]
  s_waitcnt lgkmcnt(0)
  v_mfma_f32_32x32x16_bf16 v[48:63], v[44:47], v[36:39], v[48:63]
  s_waitcnt vmcnt(3)
  s_barrier
  ds_read_b128 v[32:35], v18 offset:0
  ds_read_b64_tr_b16 v[40:41], v22 offset:0
  ds_read_b64_tr_b16 v[42:43], v22 offset:512
  ds_read_b128 v[36:39], v18 offset:2048
  ds_read_b64_tr_b16 v[44:45], v22 offset:2048
  ds_read_b64_tr_b16 v[46:47], v22 offset:2560
  s_waitcnt lgkmcnt(3)
  v_mfma_f32_32x32x16_bf16 v[48:63], v[40:43], v[32:35], v[48:63]
  ds_read_b128 v[32:35], v18 offset:4096
  ds_read_b64_tr_b16 v[40:41], v22 offset:4096
  ds_read_b64_tr_b16 v[42:43], v22 offset:4608
  s_waitcnt lgkmcnt(3)
  v_mfma_f32_32x32x16_bf16 v[48:63], v[44:47], v[36:39], v[48:63]
  ds_read_b128 v[36:39], v18 offset:6144
  ds_read_b64_tr_b16 v[44:45], v22 offset:6144
  ds_read_b64_tr_b16 v[46:47], v22 offset:6656
  s_waitcnt lgkmcnt(3)
  v_mfma_f32_32x32x16_bf16 v[48:63], v[40:43], v[32:35], v[48:63]
  s_waitcnt lgkmcnt(0)
  v_mfma_f32_32x32x16_bf16 v[48:63], v[44:47], v[36:39], v[48:63]
  s_waitcnt vmcnt(1)
  s_barrier
  ds_read_b128 v[32:35], v18 offset:32768
  ds_read_b64_tr_b16 v[40:41], v22 offset:32768
  ds_read_b64_tr_b16 v[42:43], v22 offset:33280
  ds_read_b128 v[36:39], v18 offset:34816
  ds_read_b64_tr_b16 v[44:45], v22 offset:34816
  ds_read_b64_tr_b16 v[46:47], v22 offset:35328
  s_waitcnt lgkmcnt(3)
  v_mfma_f32_32x32x16_bf16 v[48:63], v[40:43], v[32:35], v[48:63]
  ds_read_b128 v[32:35], v18 offset:36864
  ds_read_b64_tr_b16 v[40:41], v22 offset:36864
  ds_read_b64_tr_b16 v[42:43], v22 offset:37376
  s_waitcnt lgkmcnt(3)
  v_mfma_f32_32x32x16_bf16 v[48:63], v[44:47], v[36:39], v[48:63]
  ds_read_b128 v[36:39], v18 offset:38912
  ds_read_b64_tr_b16 v[44:45], v22 offset:38912
  ds_read_b64_tr_b16 v[46:47], v22 offset:39424
  s_waitcnt lgkmcnt(3)
  v_mfma_f32_32x32x16_bf16 v[48:63], v[40:43], v[32:35], v[48:63]
  s_waitcnt lgkmcnt(0)
  v_mfma_f32_32x32x16_bf16 v[48:63], v[44:47], v[36:39], v[48:63]
L_k3_oproj_kernel_kdone:
  s_barrier
  s_lshl_b32 s38, s20, 11
  v_add_u32 v5, s38, v4
  s_nop 7
  s_nop 3
  ds_write_b128 v5, v[56:59] offset:0
  ds_write_b128 v5, v[60:63] offset:1024
  s_waitcnt lgkmcnt(0)
  s_barrier
  s_xor_b32 s39, s20, 4
  s_lshl_b32 s38, s39, 11
  v_add_u32 v5, s38, v4
  ds_read_b128 v[32:35], v5 offset:0
  ds_read_b128 v[36:39], v5 offset:1024
  s_waitcnt vmcnt(0) lgkmcnt(0)
  v_permlane32_swap_b32 v28, v30
  v_permlane32_swap_b32 v29, v31
  v_lshlrev_b32 v40, 16, v28
  v_add_f32 v48, v48, v32
  v_add_f32 v48, v48, v40
  v_and_b32 v41, 0xffff0000, v28
  v_add_f32 v49, v49, v33
  v_add_f32 v49, v49, v41
  v_lshlrev_b32 v42, 16, v29
  v_add_f32 v50, v50, v34
  v_add_f32 v50, v50, v42
  v_and_b32 v43, 0xffff0000, v29
  v_add_f32 v51, v51, v35
  v_add_f32 v51, v51, v43
  v_lshlrev_b32 v44, 16, v30
  v_add_f32 v52, v52, v36
  v_add_f32 v52, v52, v44
  v_and_b32 v45, 0xffff0000, v30
  v_add_f32 v53, v53, v37
  v_add_f32 v53, v53, v45
  v_lshlrev_b32 v46, 16, v31
  v_add_f32 v54, v54, v38
  v_add_f32 v54, v54, v46
  v_and_b32 v47, 0xffff0000, v31
  v_add_f32 v55, v55, v39
  v_add_f32 v55, v55, v47
  v_cvt_pk_bf16_f32 v32, v48, v49
  v_cvt_pk_bf16_f32 v33, v50, v51
  v_cvt_pk_bf16_f32 v34, v52, v53
  v_cvt_pk_bf16_f32 v35, v54, v55
  buffer_store_dwordx4 v[32:35], v4, s[12:15], s42 offen sc1
  v_mul_f32 v25, v48, v48
  v_add_f32 v24, v48, v49
  v_fmac_f32 v25, v49, v49
  v_add_f32 v24, v24, v50
  v_fmac_f32 v25, v50, v50
  v_add_f32 v24, v24, v51
  v_fmac_f32 v25, v51, v51
  v_add_f32 v24, v24, v52
  v_fmac_f32 v25, v52, v52
  v_add_f32 v24, v24, v53
  v_fmac_f32 v25, v53, v53
  v_add_f32 v24, v24, v54
  v_fmac_f32 v25, v54, v54
  v_add_f32 v24, v24, v55
  v_fmac_f32 v25, v55, v55
  s_lshl_b32 s38, s20, 9
  v_lshlrev_b32 v6, 3, v1
  v_add_u32 v6, s38, v6
  ds_write_b64 v6, v[24:25] offset:16384
  s_add_u32 s4, s30, 16777216
  s_addc_u32 s5, s31, 0
  s_mov_b32 s6, 131072
  s_mov_b32 s7, 0x00020000
  s_lshl_b32 s44, s40, 11
  s_lshr_b32 s38, s24, 1
  s_lshl_b32 s38, s38, 9
  s_add_u32 s44, s44, s38
  s_and_b32 s38, s24, 1
  s_lshl_b32 s38, s38, 3
  s_add_u32 s44, s44, s38
  v_lshlrev_b32 v7, 4, v2
  v_lshlrev_b32 v9, 2, v3
  v_add_u32 v7, v7, v9
  s_waitcnt lgkmcnt(0)
  s_barrier
  s_cmp_ge_u32 s20, 2
  s_cbranch_scc1 L_k3_oproj_kernel_nost
  ds_read_b64 v[40:41], v6 offset:16384
  ds_read_b64 v[42:43], v6 offset:17408
  ds_read_b64 v[44:45], v6 offset:18432
  ds_read_b64 v[46:47], v6 offset:19456
  v_cmp_eq_u32 vcc, 0, v3
  s_waitcnt lgkmcnt(0)
  v_add_f32 v40, v40, v42
  v_add_f32 v41, v41, v43
  v_add_f32 v44, v44, v46
  v_add_f32 v45, v45, v47
  v_add_f32 v40, v40, v44
  v_add_f32 v41, v41, v45
  v_mov_b32 v42, v40
  v_mov_b32 v43, v41
  s_nop 1
  v_permlane32_swap_b32 v40, v42
  v_permlane32_swap_b32 v41, v43
  s_nop 1
  v_add_f32 v40, v40, v42
  v_add_f32 v41, v41, v43
  v_cndmask_b32 v40, v41, v40, vcc
  buffer_store_dword v40, v7, s[4:7], s44 offen sc1
L_k3_oproj_kernel_nost:
  s_lshr_b32 s39, s23, 1
  s_waitcnt vmcnt(0)
  s_barrier
  s_cmp_eq_u32 s20, 0
  s_cbranch_scc0 L_sig_c3
  s_lshl_b32 s56, s39, 7
  s_add_u32 s56, s56, 0
  v_mov_b32 v5, 0
  v_mov_b32 v6, 1
  s_mov_b64 exec, 1
  buffer_atomic_add v6, v5, s[52:55], s56 offen sc1
  s_mov_b64 exec, -1
L_sig_c3:
L_k3_oproj_kernel_end:
  s_load_dwordx2 s[30:31], s[0:1], 72
  s_load_dwordx2 s[32:33], s[0:1], 32
  s_load_dwordx2 s[34:35], s[0:1], 72
  s_load_dwordx2 s[36:37], s[0:1], 40
  s_and_b32 s3, s2, 7
  s_lshr_b32 s38, s2, 3
  s_lshr_b32 s23, s3, 1
  s_lshl_b32 s23, s23, 2
  s_and_b32 s39, s38, 3
  s_add_u32 s23, s23, s39
  s_and_b32 s24, s3, 1
  s_lshl_b32 s24, s24, 3
  s_lshr_b32 s39, s38, 2
  s_add_u32 s24, s24, s39
  s_cmp_ge_u32 s24, 15
  s_cbranch_scc1 L_k4_ffn1_kernel_end
  v_and_b32 v1, 63, v0
  v_lshrrev_b32 v2, 6, v0
  v_lshlrev_b32 v4, 4, v1
  v_readfirstlane_b32 s20, v2
  v_and_b32 v2, 31, v1
  v_lshrrev_b32 v3, 5, v1
  s_and_b32 s21, s20, 3
  s_lshr_b32 s22, s20, 2
  v_mul_u32_u24 v5, 43691, v1
  v_lshrrev_b32 v5, 19, v5
  v_mul_u32_u24 v6, 12, v5
  v_sub_u32 v6, v1, v6
  v_lshlrev_b32 v6, 4, v6
  s_mul_i32 s39, s24, 192
  v_add_u32 v6, s39, v6
  v_min_u32 v6, 2736, v6
  s_lshl_b32 s38, s20, 3
  v_add_u32 v5, s38, v5
  v_mul_u32_u24 v5, 2752, v5
  v_add_u32 v14, v5, v6
  s_lshl_b32 s38, s23, 2
  s_lshr_b32 s39, s20, 1
  s_add_u32 s38, s38, s39
  s_lshl_b32 s38, s38, 5
  s_and_b32 s39, s20, 1
  s_lshl_b32 s39, s39, 1
  s_add_u32 s38, s38, s39
  s_lshl_b32 s38, s38, 10
  v_add_u32 v10, s38, v4
  s_lshl_b32 s25, s20, 11
  s_mul_i32 s26, s20, 1536
  s_add_u32 s26, s26, 16384
  s_mov_b32 s46, -1
  s_mov_b32 s47, 0xffff
  s_waitcnt lgkmcnt(0)
  s_add_u32 s4, s30, 8388608
  s_addc_u32 s5, s31, 0
  s_mov_b32 s6, 2097152
  s_mov_b32 s7, 0x00020000
  s_add_u32 s12, s34, 10485760
  s_addc_u32 s13, s35, 0
  s_mov_b32 s14, 5898240
  s_mov_b32 s15, 0x00020000
  s_mov_b32 s16, s36
  s_mov_b32 s17, s37
  s_mov_b32 s18, 2752
  s_mov_b32 s19, 0x00020000
  s_mov_b32 s8, s32
  s_mov_b32 s9, s33
  s_mov_b32 s10, 1409024
  s_mov_b32 s11, 0x00020000
  s_add_u32 s52, s34, 17825792
  s_addc_u32 s53, s35, 0
  s_mov_b32 s54, 8192
  s_mov_b32 s55, 0x00020000
  s_add_u32 m0, s26, 0
  s_mov_b32 s38, 0
  s_mov_b64 exec, s[46:47]
  buffer_load_dwordx4 v14, s[8:11], s38 offen lds
  s_mov_b64 exec, -1
  s_add_u32 m0, s26, 768
  s_mov_b32 s38, 11008
  s_mov_b64 exec, s[46:47]
  buffer_load_dwordx4 v14, s[8:11], s38 offen lds
  s_mov_b64 exec, -1
  s_add_u32 m0, s26, 28672
  s_mov_b32 s38, 176128
  s_mov_b64 exec, s[46:47]
  buffer_load_dwordx4 v14, s[8:11], s38 offen lds
  s_mov_b64 exec, -1
  s_add_u32 m0, s26, 29440
  s_mov_b32 s38, 187136
  s_mov_b64 exec, s[46:47]
  buffer_load_dwordx4 v14, s[8:11], s38 offen lds
  s_mov_b64 exec, -1
  s_cmp_eq_u32 s20, 0
  s_cbranch_scc0 L_wt_c3
  s_lshl_b32 s56, s23, 7
  s_add_u32 s56, s56, 0
  v_mov_b32 v5, 0
  s_mov_b32 s57, 0
L_spin_c3:
  s_sleep 10
  buffer_load_dword v6, v5, s[52:55], s56 offen sc1
  s_add_u32 s57, s57, 1
  s_waitcnt vmcnt(0)
  v_readfirstlane_b32 s38, v6
  s_cmp_ge_u32 s57, 40000
  s_cbranch_scc1 L_wt_c3
  s_cmp_lt_u32 s38, 16
  s_cbranch_scc1 L_spin_c3
L_wt_c3:
  s_barrier
  s_add_u32 m0, s25, 0
  s_movk_i32 s38, 0
  buffer_load_dwordx4 v10, s[4:7], s38 offen offset:0 lds
  s_add_u32 m0, s25, 0
  s_movk_i32 s38, 0
  buffer_load_dwordx4 v10, s[4:7], s38 offen offset:1024 lds
  s_add_u32 m0, s25, 28672
  s_movk_i32 s38, 4096
  buffer_load_dwordx4 v10, s[4:7], s38 offen offset:0 lds
  s_add_u32 m0, s25, 28672
  s_movk_i32 s38, 4096
  buffer_load_dwordx4 v10, s[4:7], s38 offen offset:1024 lds
  s_barrier
  s_add_u32 s27, s21, 0
  s_cmp_ge_u32 s27, 3
  s_cselect_b32 s38, 3, 0
  s_sub_u32 s27, s27, s38
  s_add_u32 s28, s21, 1
  s_cmp_ge_u32 s28, 3
  s_cselect_b32 s38, 3, 0
  s_sub_u32 s28, s28, s38
  s_add_u32 s29, s21, 2
  s_cmp_ge_u32 s29, 3
  s_cselect_b32 s38, 3, 0
  s_sub_u32 s29, s29, s38
  s_lshl_b32 s38, s21, 12
  v_add_u32 v26, s38, v4
  v_add_u32 v27, 57344, v26
  v_and_b32 v5, 15, v1
  v_lshrrev_b32 v6, 2, v5
  v_lshlrev_b32 v7, 2, v3
  v_add_u32 v6, v6, v7
  v_mul_u32_u24 v6, 192, v6
  v_bfe_u32 v7, v1, 4, 1
  v_lshlrev_b32 v8, 5, v7
  v_add_u32 v6, v6, v8
  v_and_b32 v8, 3, v5
  v_lshlrev_b32 v8, 3, v8
  v_add_u32 v6, v6, v8
  s_lshl_b32 s38, s27, 6
  s_add_u32 s38, s38, 16384
  v_add_u32 v20, s38, v6
  v_add_u32 v23, 57344, v20
  s_lshl_b32 s38, s28, 6
  s_add_u32 s38, s38, 16384
  v_add_u32 v21, s38, v6
  v_add_u32 v24, 57344, v21
  s_lshl_b32 s38, s29, 6
  s_add_u32 s38, s38, 16384
  v_add_u32 v22, s38, v6
  v_add_u32 v25, 57344, v22
  v_cmp_eq_u32 vcc, v5, v7
  v_mov_b32 v9, 0x3f803f80
  v_cndmask_b32 v64, 0, v9, vcc
  v_cndmask_b32 v65, 0, v9, vcc
  v_cndmask_b32 v66, 0, v9, vcc
  v_cndmask_b32 v67, 0, v9, vcc
  v_mov_b32 v8, 0
  v_mov_b32 v9, 0
  v_mov_b32 v12, 0
  v_mov_b32 v13, 0
  v_mov_b32 v68, 0
  v_mov_b32 v69, 0
  v_mov_b32 v70, 0
  v_mov_b32 v71, 0
  v_mov_b32 v72, 0
  v_mov_b32 v73, 0
  v_mov_b32 v74, 0
  v_mov_b32 v75, 0
  v_mov_b32 v76, 0
  v_mov_b32 v77, 0
  v_mov_b32 v78, 0
  v_mov_b32 v79, 0
  v_mov_b32 v80, 0
  v_mov_b32 v81, 0
  v_mov_b32 v82, 0
  v_mov_b32 v83, 0
  v_mov_b32 v84, 0
  v_mov_b32 v85, 0
  v_mov_b32 v86, 0
  v_mov_b32 v87, 0
  v_mov_b32 v88, 0
  v_mov_b32 v89, 0
  v_mov_b32 v90, 0
  v_mov_b32 v91, 0
  v_mov_b32 v92, 0
  v_mov_b32 v93, 0
  v_mov_b32 v94, 0
  v_mov_b32 v95, 0
  v_mov_b32 v96, 0
  v_mov_b32 v97, 0
  v_mov_b32 v98, 0
  v_mov_b32 v99, 0
  v_mov_b32 v100, 0
  v_mov_b32 v101, 0
  v_mov_b32 v102, 0
  v_mov_b32 v103, 0
  s_mov_b32 s45, 0xffff0000
  s_lshl_b32 s40, s23, 2
  s_add_u32 s40, s40, s21
  s_add_u32 s48, s34, 16777216
  s_addc_u32 s49, s35, 0
  s_mov_b32 s50, 131072
  s_mov_b32 s51, 0x00020000
  s_lshl_b32 s38, s40, 11
  v_lshlrev_b32 v5, 9, v3
  v_lshlrev_b32 v6, 4, v2
  v_add_u32 v5, v5, v6
  buffer_load_dwordx4 v[120:123], v5, s[48:51], s38 offen offset:0
  buffer_load_dwordx4 v[124:127], v5, s[48:51], s38 offen offset:1024
  s_cmp_eq_u32 s22, 1
  s_cbranch_scc1 L_k4_ffn1_kernel_roleB
  s_mul_i32 s38, s24, 192
  v_lshlrev_b32 v5, 3, v3
  v_add_u32 v5, s38, v5
  s_lshl_b32 s38, s27, 6
  buffer_load_dwordx2 v[104:105], v5, s[16:19], s38 offen offset:0
  buffer_load_dwordx2 v[106:107], v5, s[16:19], s38 offen offset:16
  buffer_load_dwordx2 v[108:109], v5, s[16:19], s38 offen offset:32
  buffer_load_dwordx2 v[110:111], v5, s[16:19], s38 offen offset:48
  s_lshl_b32 s38, s28, 6
  buffer_load_dwordx2 v[112:113], v5, s[16:19], s38 offen offset:0
  buffer_load_dwordx2 v[114:115], v5, s[16:19], s38 offen offset:16
  buffer_load_dwordx2 v[116:117], v5, s[16:19], s38 offen offset:32
  buffer_load_dwordx2 v[118:119], v5, s[16:19], s38 offen offset:48
  s_waitcnt vmcnt(12)
  s_barrier
  ds_read_b128 v[40:43], v26 offset:0
  ds_read_b64_tr_b16 v[48:49], v20 offset:0
  ds_read_b64_tr_b16 v[50:51], v20 offset:1536
  ds_read_b64_tr_b16 v[52:53], v21 offset:0
  ds_read_b64_tr_b16 v[54:55], v21 offset:1536
  ds_read_b128 v[44:47], v26 offset:1024
  ds_read_b64_tr_b16 v[56:57], v20 offset:3072
  ds_read_b64_tr_b16 v[58:59], v20 offset:4608
  ds_read_b64_tr_b16 v[60:61], v21 offset:3072
  ds_read_b64_tr_b16 v[62:63], v21 offset:4608
  s_waitcnt lgkmcnt(5)
  v_mfma_f32_32x32x16_bf16 v[72:87], v[48:51], v[40:43], v[72:87]
  s_add_u32 m0, s25, 57344
  s_movk_i32 s38, 8192
  buffer_load_dwordx4 v10, s[4:7], s38 offen offset:0 lds
  s_add_u32 m0, s25, 57344
  s_movk_i32 s38, 8192
  buffer_load_dwordx4 v10, s[4:7], s38 offen offset:1024 lds
  v_mfma_f32_32x32x16_bf16 v[88:103], v[52:55], v[40:43], v[88:103]
  v_mfma_f32_16x16x32_bf16 v[68:71], v[48:51], v[64:67], v[68:71]
  ds_read_b128 v[40:43], v26 offset:2048
  ds_read_b64_tr_b16 v[48:49], v20 offset:6144
  ds_read_b64_tr_b16 v[50:51], v20 offset:7680
  ds_read_b64_tr_b16 v[52:53], v21 offset:6144
  ds_read_b64_tr_b16 v[54:55], v21 offset:7680
  s_waitcnt lgkmcnt(5)
  v_mfma_f32_32x32x16_bf16 v[72:87], v[56:59], v[44:47], v[72:87]
  s_add_u32 m0, s26, 57344
  s_mov_b32 s38, 352256
  s_mov_b64 exec, s[46:47]
  buffer_load_dwordx4 v14, s[8:11], s38 offen lds
  s_mov_b64 exec, -1
  v_mfma_f32_32x32x16_bf16 v[88:103], v[60:63], v[44:47], v[88:103]
  v_mfma_f32_16x16x32_bf16 v[68:71], v[56:59], v[64:67], v[68:71]
  ds_read_b128 v[44:47], v26 offset:3072
  ds_read_b64_tr_b16 v[56:57], v20 offset:9216
  ds_read_b64_tr_b16 v[58:59], v20 offset:10752
  ds_read_b64_tr_b16 v[60:61], v21 offset:9216
  ds_read_b64_tr_b16 v[62:63], v21 offset:10752
  s_waitcnt lgkmcnt(5)
  v_mfma_f32_32x32x16_bf16 v[72:87], v[48:51], v[40:43], v[72:87]
  s_add_u32 m0, s26, 58112
  s_mov_b32 s38, 363264
  s_mov_b64 exec, s[46:47]
  buffer_load_dwordx4 v14, s[8:11], s38 offen lds
  s_mov_b64 exec, -1
  v_mfma_f32_32x32x16_bf16 v[88:103], v[52:55], v[40:43], v[88:103]
  v_mfma_f32_16x16x32_bf16 v[68:71], v[48:51], v[64:67], v[68:71]
  s_waitcnt vmcnt(14)
  s_barrier
  ds_read_b128 v[40:43], v26 offset:28672
  ds_read_b64_tr_b16 v[48:49], v20 offset:28672
  ds_read_b64_tr_b16 v[50:51], v20 offset:30208
  ds_read_b64_tr_b16 v[52:53], v21 offset:28672
  ds_read_b64_tr_b16 v[54:55], v21 offset:30208
  s_waitcnt lgkmcnt(5)
  v_mfma_f32_32x32x16_bf16 v[72:87], v[56:59], v[44:47], v[72:87]
  s_add_u32 m0, s25, 86016
  s_movk_i32 s38, 12288
  buffer_load_dwordx4 v10, s[4:7], s38 offen offset:0 lds
  v_mfma_f32_32x32x16_bf16 v[88:103], v[60:63], v[44:47], v[88:103]
  v_mfma_f32_16x16x32_bf16 v[68:71], v[56:59], v[64:67], v[68:71]
  ds_read_b128 v[44:47], v26 offset:29696
  ds_read_b64_tr_b16 v[56:57], v20 offset:31744
  ds_read_b64_tr_b16 v[58:59], v20 offset:33280
  ds_read_b64_tr_b16 v[60:61], v21 offset:31744
  ds_read_b64_tr_b16 v[62:63], v21 offset:33280
  s_waitcnt lgkmcnt(5)
  v_mfma_f32_32x32x16_bf16 v[72:87], v[48:51], v[40:43], v[72:87]
  s_add_u32 m0, s25, 86016
  s_movk_i32 s38, 12288
  buffer_load_dwordx4 v10, s[4:7], s38 offen offset:1024 lds
  v_mfma_f32_32x32x16_bf16 v[88:103], v[52:55], v[40:43], v[88:103]
  v_mfma_f32_16x16x32_bf16 v[68:71], v[48:51], v[64:67], v[68:71]
  ds_read_b128 v[40:43], v26 offset:30720
  ds_read_b64_tr_b16 v[48:49], v20 offset:34816
  ds_read_b64_tr_b16 v[50:51], v20 offset:36352
  ds_read_b64_tr_b16 v[52:53], v21 offset:34816
  ds_read_b64_tr_b16 v[54:55], v21 offset:36352
  s_waitcnt lgkmcnt(5)
  v_mfma_f32_32x32x16_bf16 v[72:87], v[56:59], v[44:47], v[72:87]
  s_add_u32 m0, s26, 86016
  s_mov_b32 s38, 528384
  s_mov_b64 exec, s[46:47]
  buffer_load_dwordx4 v14, s[8:11], s38 offen lds
  s_mov_b64 exec, -1
  v_mfma_f32_32x32x16_bf16 v[88:103], v[60:63], v[44:47], v[88:103]
  v_mfma_f32_16x16x32_bf16 v[68:71], v[56:59], v[64:67], v[68:71]
  ds_read_b128 v[44:47], v26 offset:31744
  ds_read_b64_tr_b16 v[56:57], v20 offset:37888
  ds_read_b64_tr_b16 v[58:59], v20 offset:39424
  ds_read_b64_tr_b16 v[60:61], v21 offset:37888
  ds_read_b64_tr_b16 v[62:63], v21 offset:39424
  s_waitcnt lgkmcnt(5)
  v_mfma_f32_32x32x16_bf16 v[72:87], v[48:51], v[40:43], v[72:87]
  s_add_u32 m0, s26, 86784
  s_mov_b32 s38, 539392
  s_mov_b64 exec, s[46:47]
  buffer_load_dwordx4 v14, s[8:11], s38 offen lds
  s_mov_b64 exec, -1
  v_mfma_f32_32x32x16_bf16 v[88:103], v[52:55], v[40:43], v[88:103]
  v_mfma_f32_16x16x32_bf16 v[68:71], v[48:51], v[64:67], v[68:71]
  s_waitcnt vmcnt(4)
  s_barrier
  ds_read_b128 v[40:43], v27 offset:0
  ds_read_b64_tr_b16 v[48:49], v23 offset:0
  ds_read_b64_tr_b16 v[50:51], v23 offset:1536
  ds_read_b64_tr_b16 v[52:53], v24 offset:0
  ds_read_b64_tr_b16 v[54:55], v24 offset:1536
  s_waitcnt lgkmcnt(5)
  v_mfma_f32_32x32x16_bf16 v[72:87], v[56:59], v[44:47], v[72:87]
  s_add_u32 m0, s25, 0
  s_movk_i32 s38, 16384
  buffer_load_dwordx4 v10, s[4:7], s38 offen offset:0 lds
  v_mfma_f32_32x32x16_bf16 v[88:103], v[60:63], v[44:47], v[88:103]
  v_mfma_f32_16x16x32_bf16 v[68:71], v[56:59], v[64:67], v[68:71]
  ds_read_b128 v[44:47], v27 offset:1024
  ds_read_b64_tr_b16 v[56:57], v23 offset:3072
  ds_read_b64_tr_b16 v[58:59], v23 offset:4608
  ds_read_b64_tr_b16 v[60:61], v24 offset:3072
  ds_read_b64_tr_b16 v[62:63], v24 offset:4608
  s_waitcnt lgkmcnt(5)
  v_mfma_f32_32x32x16_bf16 v[72:87], v[48:51], v[40:43], v[72:87]
  s_add_u32 m0, s25, 0
  s_movk_i32 s38, 16384
  buffer_load_dwordx4 v10, s[4:7], s38 offen offset:1024 lds
  v_mfma_f32_32x32x16_bf16 v[88:103], v[52:55], v[40:43], v[88:103]
  v_mfma_f32_16x16x32_bf16 v[68:71], v[48:51], v[64:67], v[68:71]
  ds_read_b128 v[40:43], v27 offset:2048
  ds_read_b64_tr_b16 v[48:49], v23 offset:6144
  ds_read_b64_tr_b16 v[50:51], v23 offset:7680
  ds_read_b64_tr_b16 v[52:53], v24 offset:6144
  ds_read_b64_tr_b16 v[54:55], v24 offset:7680
  s_waitcnt lgkmcnt(5)
  v_mfma_f32_32x32x16_bf16 v[72:87], v[56:59], v[44:47], v[72:87]
  s_add_u32 m0, s26, 0
  s_mov_b32 s38, 704512
  s_mov_b64 exec, s[46:47]
  buffer_load_dwordx4 v14, s[8:11], s38 offen lds
  s_mov_b64 exec, -1
  v_mfma_f32_32x32x16_bf16 v[88:103], v[60:63], v[44:47], v[88:103]
  v_mfma_f32_16x16x32_bf16 v[68:71], v[56:59], v[64:67], v[68:71]
  ds_read_b128 v[44:47], v27 offset:3072
  ds_read_b64_tr_b16 v[56:57], v23 offset:9216
  ds_read_b64_tr_b16 v[58:59], v23 offset:10752
  ds_read_b64_tr_b16 v[60:61], v24 offset:9216
  ds_read_b64_tr_b16 v[62:63], v24 offset:10752
  s_waitcnt lgkmcnt(5)
  v_mfma_f32_32x32x16_bf16 v[72:87], v[48:51], v[40:43], v[72:87]
  s_add_u32 m0, s26, 768
  s_mov_b32 s38, 715520
  s_mov_b64 exec, s[46:47]
  buffer_load_dwordx4 v14, s[8:11], s38 offen lds
  s_mov_b64 exec, -1
  v_mfma_f32_32x32x16_bf16 v[88:103], v[52:55], v[40:43], v[88:103]
  v_mfma_f32_16x16x32_bf16 v[68:71], v[48:51], v[64:67], v[68:71]
  s_waitcnt vmcnt(4)
  s_barrier
  ds_read_b128 v[40:43], v27 offset:28672
  ds_read_b64_tr_b16 v[48:49], v23 offset:28672
  ds_read_b64_tr_b16 v[50:51], v23 offset:30208
  ds_read_b64_tr_b16 v[52:53], v24 offset:28672
  ds_read_b64_tr_b16 v[54:55], v24 offset:30208
  s_waitcnt lgkmcnt(5)
  v_mfma_f32_32x32x16_bf16 v[72:87], v[56:59], v[44:47], v[72:87]
  s_add_u32 m0, s25, 28672
  s_movk_i32 s38, 20480
  buffer_load_dwordx4 v10, s[4:7], s38 offen offset:0 lds
  v_mfma_f32_32x32x16_bf16 v[88:103], v[60:63], v[44:47], v[88:103]
  v_mfma_f32_16x16x32_bf16 v[68:71], v[56:59], v[64:67], v[68:71]
  ds_read_b128 v[44:47], v27 offset:29696
  ds_read_b64_tr_b16 v[56:57], v23 offset:31744
  ds_read_b64_tr_b16 v[58:59], v23 offset:33280
  ds_read_b64_tr_b16 v[60:61], v24 offset:31744
  ds_read_b64_tr_b16 v[62:63], v24 offset:33280
  s_waitcnt lgkmcnt(5)
  v_mfma_f32_32x32x16_bf16 v[72:87], v[48:51], v[40:43], v[72:87]
  s_add_u32 m0, s25, 28672
  s_movk_i32 s38, 20480
  buffer_load_dwordx4 v10, s[4:7], s38 offen offset:1024 lds
  v_mfma_f32_32x32x16_bf16 v[88:103], v[52:55], v[40:43], v[88:103]
  v_mfma_f32_16x16x32_bf16 v[68:71], v[48:51], v[64:67], v[68:71]
  ds_read_b128 v[40:43], v27 offset:30720
  ds_read_b64_tr_b16 v[48:49], v23 offset:34816
  ds_read_b64_tr_b16 v[50:51], v23 offset:36352
  ds_read_b64_tr_b16 v[52:53], v24 offset:34816
  ds_read_b64_tr_b16 v[54:55], v24 offset:36352
  s_waitcnt lgkmcnt(5)
  v_mfma_f32_32x32x16_bf16 v[72:87], v[56:59], v[44:47], v[72:87]
  s_add_u32 m0, s26, 28672
  s_mov_b32 s38, 880640
  s_mov_b64 exec, s[46:47]
  buffer_load_dwordx4 v14, s[8:11], s38 offen lds
  s_mov_b64 exec, -1
  v_mfma_f32_32x32x16_bf16 v[88:103], v[60:63], v[44:47], v[88:103]
  v_mfma_f32_16x16x32_bf16 v[68:71], v[56:59], v[64:67], v[68:71]
  ds_read_b128 v[44:47], v27 offset:31744
  ds_read_b64_tr_b16 v[56:57], v23 offset:37888
  ds_read_b64_tr_b16 v[58:59], v23 offset:39424
  ds_read_b64_tr_b16 v[60:61], v24 offset:37888
  ds_read_b64_tr_b16 v[62:63], v24 offset:39424
  s_waitcnt lgkmcnt(5)
  v_mfma_f32_32x32x16_bf16 v[72:87], v[48:51], v[40:43], v[72:87]
  s_add_u32 m0, s26, 29440
  s_mov_b32 s38, 891648
  s_mov_b64 exec, s[46:47]
  buffer_load_dwordx4 v14, s[8:11], s38 offen lds
  s_mov_b64 exec, -1
  v_mfma_f32_32x32x16_bf16 v[88:103], v[52:55], v[40:43], v[88:103]
  v_mfma_f32_16x16x32_bf16 v[68:71], v[48:51], v[64:67], v[68:71]
  s_waitcnt vmcnt(4)
  s_barrier
  ds_read_b128 v[40:43], v26 offset:0
  ds_read_b64_tr_b16 v[48:49], v20 offset:0
  ds_read_b64_tr_b16 v[50:51], v20 offset:1536
  ds_read_b64_tr_b16 v[52:53], v21 offset:0
  ds_read_b64_tr_b16 v[54:55], v21 offset:1536
  s_waitcnt lgkmcnt(5)
  v_mfma_f32_32x32x16_bf16 v[72:87], v[56:59], v[44:47], v[72:87]
  s_add_u32 m0, s25, 57344
  s_movk_i32 s38, 24576
  buffer_load_dwordx4 v10, s[4:7], s38 offen offset:0 lds
  v_mfma_f32_32x32x16_bf16 v[88:103], v[60:63], v[44:47], v[88:103]
  v_mfma_f32_16x16x32_bf16 v[68:71], v[56:59], v[64:67], v[68:71]
  ds_read_b128 v[44:47], v26 offset:1024
  ds_read_b64_tr_b16 v[56:57], v20 offset:3072
  ds_read_b64_tr_b16 v[58:59], v20 offset:4608
  ds_read_b64_tr_b16 v[60:61], v21 offset:3072
  ds_read_b64_tr_b16 v[62:63], v21 offset:4608
  s_waitcnt lgkmcnt(5)
  v_mfma_f32_32x32x16_bf16 v[72:87], v[48:51], v[40:43], v[72:87]
  s_add_u32 m0, s25, 57344
  s_movk_i32 s38, 24576
  buffer_load_dwordx4 v10, s[4:7], s38 offen offset:1024 lds
  v_mfma_f32_32x32x16_bf16 v[88:103], v[52:55], v[40:43], v[88:103]
  v_mfma_f32_16x16x32_bf16 v[68:71], v[48:51], v[64:67], v[68:71]
  ds_read_b128 v[40:43], v26 offset:2048
  ds_read_b64_tr_b16 v[48:49], v20 offset:6144
  ds_read_b64_tr_b16 v[50:51], v20 offset:7680
  ds_read_b64_tr_b16 v[52:53], v21 offset:6144
  ds_read_b64_tr_b16 v[54:55], v21 offset:7680
  s_waitcnt lgkmcnt(5)
  v_mfma_f32_32x32x16_bf16 v[72:87], v[56:59], v[44:47], v[72:87]
  s_add_u32 m0, s26, 57344
  s_mov_b32 s38, 1056768
  s_mov_b64 exec, s[46:47]
  buffer_load_dwordx4 v14, s[8:11], s38 offen lds
  s_mov_b64 exec, -1
  v_mfma_f32_32x32x16_bf16 v[88:103], v[60:63], v[44:47], v[88:103]
  v_mfma_f32_16x16x32_bf16 v[68:71], v[56:59], v[64:67], v[68:71]
  ds_read_b128 v[44:47], v26 offset:3072
  ds_read_b64_tr_b16 v[56:57], v20 offset:9216
  ds_read_b64_tr_b16 v[58:59], v20 offset:10752
  ds_read_b64_tr_b16 v[60:61], v21 offset:9216
  ds_read_b64_tr_b16 v[62:63], v21 offset:10752
  s_waitcnt lgkmcnt(5)
  v_mfma_f32_32x32x16_bf16 v[72:87], v[48:51], v[40:43], v[72:87]
  s_add_u32 m0, s26, 58112
  s_mov_b32 s38, 1067776
  s_mov_b64 exec, s[46:47]
  buffer_load_dwordx4 v14, s[8:11], s38 offen lds
  s_mov_b64 exec, -1
  v_mfma_f32_32x32x16_bf16 v[88:103], v[52:55], v[40:43], v[88:103]
  v_mfma_f32_16x16x32_bf16 v[68:71], v[48:51], v[64:67], v[68:71]
  s_waitcnt vmcnt(4)
  s_barrier
  ds_read_b128 v[40:43], v26 offset:28672
  ds_read_b64_tr_b16 v[48:49], v20 offset:28672
  ds_read_b64_tr_b16 v[50:51], v20 offset:30208
  ds_read_b64_tr_b16 v[52:53], v21 offset:28672
  ds_read_b64_tr_b16 v[54:55], v21 offset:30208
  s_waitcnt lgkmcnt(5)
  v_mfma_f32_32x32x16_bf16 v[72:87], v[56:59], v[44:47], v[72:87]
  s_add_u32 m0, s25, 86016
  s_movk_i32 s38, 28672
  buffer_load_dwordx4 v10, s[4:7], s38 offen offset:0 lds
  v_mfma_f32_32x32x16_bf16 v[88:103], v[60:63], v[44:47], v[88:103]
  v_mfma_f32_16x16x32_bf16 v[68:71], v[56:59], v[64:67], v[68:71]
  ds_read_b128 v[44:47], v26 offset:29696
  ds_read_b64_tr_b16 v[56:57], v20 offset:31744
  ds_read_b64_tr_b16 v[58:59], v20 offset:33280
  ds_read_b64_tr_b16 v[60:61], v21 offset:31744
  ds_read_b64_tr_b16 v[62:63], v21 offset:33280
  s_waitcnt lgkmcnt(5)
  v_mfma_f32_32x32x16_bf16 v[72:87], v[48:51], v[40:43], v[72:87]
  s_add_u32 m0, s25, 86016
  s_movk_i32 s38, 28672
  buffer_load_dwordx4 v10, s[4:7], s38 offen offset:1024 lds
  v_mfma_f32_32x32x16_bf16 v[88:103], v[52:55], v[40:43], v[88:103]
  v_mfma_f32_16x16x32_bf16 v[68:71], v[48:51], v[64:67], v[68:71]
  ds_read_b128 v[40:43], v26 offset:30720
  ds_read_b64_tr_b16 v[48:49], v20 offset:34816
  ds_read_b64_tr_b16 v[50:51], v20 offset:36352
  ds_read_b64_tr_b16 v[52:53], v21 offset:34816
  ds_read_b64_tr_b16 v[54:55], v21 offset:36352
  s_waitcnt lgkmcnt(5)
  v_mfma_f32_32x32x16_bf16 v[72:87], v[56:59], v[44:47], v[72:87]
  s_add_u32 m0, s26, 86016
  s_mov_b32 s38, 1232896
  s_mov_b64 exec, s[46:47]
  buffer_load_dwordx4 v14, s[8:11], s38 offen lds
  s_mov_b64 exec, -1
  v_mfma_f32_32x32x16_bf16 v[88:103], v[60:63], v[44:47], v[88:103]
  v_mfma_f32_16x16x32_bf16 v[68:71], v[56:59], v[64:67], v[68:71]
  ds_read_b128 v[44:47], v26 offset:31744
  ds_read_b64_tr_b16 v[56:57], v20 offset:37888
  ds_read_b64_tr_b16 v[58:59], v20 offset:39424
  ds_read_b64_tr_b16 v[60:61], v21 offset:37888
  ds_read_b64_tr_b16 v[62:63], v21 offset:39424
  s_waitcnt lgkmcnt(5)
  v_mfma_f32_32x32x16_bf16 v[72:87], v[48:51], v[40:43], v[72:87]
  s_add_u32 m0, s26, 86784
  s_mov_b32 s38, 1243904
  s_mov_b64 exec, s[46:47]
  buffer_load_dwordx4 v14, s[8:11], s38 offen lds
  s_mov_b64 exec, -1
  v_mfma_f32_32x32x16_bf16 v[88:103], v[52:55], v[40:43], v[88:103]
  v_mfma_f32_16x16x32_bf16 v[68:71], v[48:51], v[64:67], v[68:71]
  s_waitcnt vmcnt(4)
  s_barrier
  ds_read_b128 v[40:43], v27 offset:0
  ds_read_b64_tr_b16 v[48:49], v23 offset:0
  ds_read_b64_tr_b16 v[50:51], v23 offset:1536
  ds_read_b64_tr_b16 v[52:53], v24 offset:0
  ds_read_b64_tr_b16 v[54:55], v24 offset:1536
  s_waitcnt lgkmcnt(5)
  v_mfma_f32_32x32x16_bf16 v[72:87], v[56:59], v[44:47], v[72:87]
  v_mfma_f32_32x32x16_bf16 v[88:103], v[60:63], v[44:47], v[88:103]
  v_mfma_f32_16x16x32_bf16 v[68:71], v[56:59], v[64:67], v[68:71]
  ds_read_b128 v[44:47], v27 offset:1024
  ds_read_b64_tr_b16 v[56:57], v23 offset:3072
  ds_read_b64_tr_b16 v[58:59], v23 offset:4608
  ds_read_b64_tr_b16 v[60:61], v24 offset:3072
  ds_read_b64_tr_b16 v[62:63], v24 offset:4608
  s_waitcnt lgkmcnt(5)
  v_mfma_f32_32x32x16_bf16 v[72:87], v[48:51], v[40:43], v[72:87]
  v_mfma_f32_32x32x16_bf16 v[88:103], v[52:55], v[40:43], v[88:103]
  v_mfma_f32_16x16x32_bf16 v[68:71], v[48:51], v[64:67], v[68:71]
  ds_read_b128 v[40:43], v27 offset:2048
  ds_read_b64_tr_b16 v[48:49], v23 offset:6144
  ds_read_b64_tr_b16 v[50:51], v23 offset:7680
  ds_read_b64_tr_b16 v[52:53], v24 offset:6144
  ds_read_b64_tr_b16 v[54:55], v24 offset:7680
  s_waitcnt lgkmcnt(5)
  v_mfma_f32_32x32x16_bf16 v[72:87], v[56:59], v[44:47], v[72:87]
  v_mfma_f32_32x32x16_bf16 v[88:103], v[60:63], v[44:47], v[88:103]
  v_mfma_f32_16x16x32_bf16 v[68:71], v[56:59], v[64:67], v[68:71]
  ds_read_b128 v[44:47], v27 offset:3072
  ds_read_b64_tr_b16 v[56:57], v23 offset:9216
  ds_read_b64_tr_b16 v[58:59], v23 offset:10752
  ds_read_b64_tr_b16 v[60:61], v24 offset:9216
  ds_read_b64_tr_b16 v[62:63], v24 offset:10752
  s_waitcnt lgkmcnt(5)
  v_mfma_f32_32x32x16_bf16 v[72:87], v[48:51], v[40:43], v[72:87]
  v_mfma_f32_32x32x16_bf16 v[88:103], v[52:55], v[40:43], v[88:103]
  v_mfma_f32_16x16x32_bf16 v[68:71], v[48:51], v[64:67], v[68:71]
  s_waitcnt vmcnt(0)
  s_barrier
  ds_read_b128 v[40:43], v27 offset:28672
  ds_read_b64_tr_b16 v[48:49], v23 offset:28672
  ds_read_b64_tr_b16 v[50:51], v23 offset:30208
  ds_read_b64_tr_b16 v[52:53], v24 offset:28672
  ds_read_b64_tr_b16 v[54:55], v24 offset:30208
  s_waitcnt lgkmcnt(5)
  v_mfma_f32_32x32x16_bf16 v[72:87], v[56:59], v[44:47], v[72:87]
  v_mfma_f32_32x32x16_bf16 v[88:103], v[60:63], v[44:47], v[88:103]
  v_mfma_f32_16x16x32_bf16 v[68:71], v[56:59], v[64:67], v[68:71]
  ds_read_b128 v[44:47], v27 offset:29696
  ds_read_b64_tr_b16 v[56:57], v23 offset:31744
  ds_read_b64_tr_b16 v[58:59], v23 offset:33280
  ds_read_b64_tr_b16 v[60:61], v24 offset:31744
  ds_read_b64_tr_b16 v[62:63], v24 offset:33280
  s_waitcnt lgkmcnt(5)
  v_mfma_f32_32x32x16_bf16 v[72:87], v[48:51], v[40:43], v[72:87]
  v_mfma_f32_32x32x16_bf16 v[88:103], v[52:55], v[40:43], v[88:103]
  v_mfma_f32_16x16x32_bf16 v[68:71], v[48:51], v[64:67], v[68:71]
  ds_read_b128 v[40:43], v27 offset:30720
  ds_read_b64_tr_b16 v[48:49], v23 offset:34816
  ds_read_b64_tr_b16 v[50:51], v23 offset:36352
  ds_read_b64_tr_b16 v[52:53], v24 offset:34816
  ds_read_b64_tr_b16 v[54:55], v24 offset:36352
  s_waitcnt lgkmcnt(5)
  v_mfma_f32_32x32x16_bf16 v[72:87], v[56:59], v[44:47], v[72:87]
  v_mfma_f32_32x32x16_bf16 v[88:103], v[60:63], v[44:47], v[88:103]
  v_mfma_f32_16x16x32_bf16 v[68:71], v[56:59], v[64:67], v[68:71]
  ds_read_b128 v[44:47], v27 offset:31744
  ds_read_b64_tr_b16 v[56:57], v23 offset:37888
  ds_read_b64_tr_b16 v[58:59], v23 offset:39424
  ds_read_b64_tr_b16 v[60:61], v24 offset:37888
  ds_read_b64_tr_b16 v[62:63], v24 offset:39424
  s_waitcnt lgkmcnt(5)
  v_mfma_f32_32x32x16_bf16 v[72:87], v[48:51], v[40:43], v[72:87]
  v_mfma_f32_32x32x16_bf16 v[88:103], v[52:55], v[40:43], v[88:103]
  v_mfma_f32_16x16x32_bf16 v[68:71], v[48:51], v[64:67], v[68:71]
  s_waitcnt lgkmcnt(0)
  v_mfma_f32_32x32x16_bf16 v[72:87], v[56:59], v[44:47], v[72:87]
  v_mfma_f32_32x32x16_bf16 v[88:103], v[60:63], v[44:47], v[88:103]
  v_mfma_f32_16x16x32_bf16 v[68:71], v[56:59], v[64:67], v[68:71]
  v_and_b32 v10, 15, v1
  v_lshlrev_b32 v10, 6, v10
  v_lshrrev_b32 v11, 4, v1
  v_lshlrev_b32 v11, 4, v11
  v_add_u32 v10, v10, v11
  s_lshl_b32 s39, s27, 7
  v_add_u32 v10, s39, v10
  s_mov_b32 s46, 0x00030003
  s_mov_b32 s47, 0x00030003
  s_nop 3
  s_mov_b64 exec, s[46:47]
  ds_write_b128 v10, v[68:71] offset:4096
  s_mov_b64 exec, -1
  s_lshl_b32 s38, s21, 8
  v_lshlrev_b32 v7, 3, v2
  v_add_u32 v7, s38, v7
  v_add_f32 v8, v120, v122
  v_add_f32 v9, v121, v123
  v_add_f32 v12, v124, v126
  v_add_f32 v13, v125, v127
  v_add_f32 v8, v8, v12
  v_add_f32 v9, v9, v13
  v_mov_b32 v12, v8
  v_mov_b32 v13, v9
  s_nop 1
  v_permlane32_swap_b32 v8, v12
  v_permlane32_swap_b32 v9, v13
  s_nop 1
  v_add_f32 v8, v8, v12
  v_add_f32 v9, v9, v13
  v_mul_f32 v22, 0x3b000000, v8
  v_mul_f32 v23, 0x3b000000, v9
  v_fma_f32 v23, -v22, v22, v23
  v_max_f32 v23, 0, v23
  v_add_f32 v23, 0x3727c5ac, v23
  v_rsq_f32 v23, v23
  s_nop 0
  v_mul_f32 v22, v22, v23
  v_lshlrev_b32 v10, 4, v3
  v_lshlrev_b32 v15, 5, v2
  v_add_u32 v15, v15, v10
  s_lshl_b32 s38, s27, 7
  v_add_u32 v16, s38, v10
  s_lshl_b32 s38, s28, 7
  v_add_u32 v17, s38, v10
  s_waitcnt lgkmcnt(0)
  s_barrier
  ds_read_b128 v[120:123], v16 offset:4096
  ds_read_b128 v[124:127], v16 offset:4128
  ds_read_b128 v[26:29], v16 offset:4160
  ds_read_b128 v[30:33], v16 offset:4192
  s_waitcnt lgkmcnt(2)
  s_mul_i32 s41, s24, 6
  s_lshl_b32 s38, s27, 1
  s_add_u32 s41, s41, s38
  s_mul_i32 s42, s40, 90
  s_add_u32 s42, s42, s41
  s_lshl_b32 s42, s42, 10
  v_lshlrev_b32 v48, 16, v104
  v_and_b32 v49, s45, v104
  v_lshlrev_b32 v50, 16, v105
  v_and_b32 v51, s45, v105
  v_lshlrev_b32 v52, 16, v106
  v_and_b32 v53, s45, v106
  v_lshlrev_b32 v54, 16, v107
  v_and_b32 v55, s45, v107
  v_fma_f32 v48, -v22, v120, v48
  v_fma_f32 v49, -v22, v121, v49
  v_fma_f32 v50, -v22, v122, v50
  v_fma_f32 v51, -v22, v123, v51
  v_fma_f32 v52, -v22, v124, v52
  v_fma_f32 v53, -v22, v125, v53
  v_fma_f32 v54, -v22, v126, v54
  v_fma_f32 v55, -v22, v127, v55
  ds_read_b128 v[120:123], v17 offset:4096
  ds_read_b128 v[124:127], v17 offset:4128
  v_fma_f32 v72, v23, v72, v48
  v_fma_f32 v73, v23, v73, v49
  v_fma_f32 v74, v23, v74, v50
  v_fma_f32 v75, v23, v75, v51
  v_fma_f32 v76, v23, v76, v52
  v_fma_f32 v77, v23, v77, v53
  v_fma_f32 v78, v23, v78, v54
  v_fma_f32 v79, v23, v79, v55
  v_mul_f32 v48, 0x3fb8aa3b, v72
  v_mul_f32 v49, 0x3fb8aa3b, v73
  v_mul_f32 v50, 0x3fb8aa3b, v74
  v_mul_f32 v51, 0x3fb8aa3b, v75
  v_mul_f32 v52, 0x3fb8aa3b, v76
  v_mul_f32 v53, 0x3fb8aa3b, v77
  v_mul_f32 v54, 0x3fb8aa3b, v78
  v_mul_f32 v55, 0x3fb8aa3b, v79
  v_exp_f32 v48, v48
  v_exp_f32 v49, v49
  v_exp_f32 v50, v50
  v_exp_f32 v51, v51
  v_exp_f32 v52, v52
  v_exp_f32 v53, v53
  v_exp_f32 v54, v54
  v_exp_f32 v55, v55
  v_add_f32 v56, 2.0, v48
  v_add_f32 v57, 2.0, v49
  v_add_f32 v58, 2.0, v50
  v_add_f32 v59, 2.0, v51
  v_add_f32 v60, 2.0, v52
  v_add_f32 v61, 2.0, v53
  v_add_f32 v62, 2.0, v54
  v_add_f32 v63, 2.0, v55
  v_fma_f32 v56, v48, v56, 2.0
  v_fma_f32 v57, v49, v57, 2.0
  v_fma_f32 v58, v50, v58, 2.0
  v_fma_f32 v59, v51, v59, 2.0
  v_fma_f32 v60, v52, v60, 2.0
  v_fma_f32 v61, v53, v61, 2.0
  v_fma_f32 v62, v54, v62, 2.0
  v_fma_f32 v63, v55, v63, 2.0
  v_rcp_f32 v56, v56
  v_rcp_f32 v57, v57
  v_rcp_f32 v58, v58
  v_rcp_f32 v59, v59
  v_rcp_f32 v60, v60
  v_rcp_f32 v61, v61
  v_rcp_f32 v62, v62
  v_rcp_f32 v63, v63
  v_mul_f32 v56, v72, v56
  v_mul_f32 v57, v73, v57
  v_mul_f32 v58, v74, v58
  v_mul_f32 v59, v75, v59
  v_mul_f32 v60, v76, v60
  v_mul_f32 v61, v77, v61
  v_mul_f32 v62, v78, v62
  v_mul_f32 v63, v79, v63
  v_fma_f32 v72, -2.0, v56, v72
  v_fma_f32 v73, -2.0, v57, v73
  v_fma_f32 v74, -2.0, v58, v74
  v_fma_f32 v75, -2.0, v59, v75
  v_fma_f32 v76, -2.0, v60, v76
  v_fma_f32 v77, -2.0, v61, v77
  v_fma_f32 v78, -2.0, v62, v78
  v_fma_f32 v79, -2.0, v63, v79
  v_cvt_pk_bf16_f32 v40, v72, v73
  v_cvt_pk_bf16_f32 v41, v74, v75
  v_cvt_pk_bf16_f32 v42, v76, v77
  v_cvt_pk_bf16_f32 v43, v78, v79
  buffer_store_dwordx4 v[40:43], v4, s[12:15], s42 offen sc1
  s_waitcnt lgkmcnt(2)
  s_mul_i32 s41, s24, 6
  s_lshl_b32 s38, s27, 1
  s_add_u32 s41, s41, s38
  s_add_u32 s41, s41, 1
  s_mul_i32 s42, s40, 90
  s_add_u32 s42, s42, s41
  s_lshl_b32 s42, s42, 10
  v_lshlrev_b32 v48, 16, v108
  v_and_b32 v49, s45, v108
  v_lshlrev_b32 v50, 16, v109
  v_and_b32 v51, s45, v109
  v_lshlrev_b32 v52, 16, v110
  v_and_b32 v53, s45, v110
  v_lshlrev_b32 v54, 16, v111
  v_and_b32 v55, s45, v111
  v_fma_f32 v48, -v22, v26, v48
  v_fma_f32 v49, -v22, v27, v49
  v_fma_f32 v50, -v22, v28, v50
  v_fma_f32 v51, -v22, v29, v51
  v_fma_f32 v52, -v22, v30, v52
  v_fma_f32 v53, -v22, v31, v53
  v_fma_f32 v54, -v22, v32, v54
  v_fma_f32 v55, -v22, v33, v55
  ds_read_b128 v[26:29], v17 offset:4160
  ds_read_b128 v[30:33], v17 offset:4192
  v_fma_f32 v80, v23, v80, v48
  v_fma_f32 v81, v23, v81, v49
  v_fma_f32 v82, v23, v82, v50
  v_fma_f32 v83, v23, v83, v51
  v_fma_f32 v84, v23, v84, v52
  v_fma_f32 v85, v23, v85, v53
  v_fma_f32 v86, v23, v86, v54
  v_fma_f32 v87, v23, v87, v55
  v_mul_f32 v48, 0x3fb8aa3b, v80
  v_mul_f32 v49, 0x3fb8aa3b, v81
  v_mul_f32 v50, 0x3fb8aa3b, v82
  v_mul_f32 v51, 0x3fb8aa3b, v83
  v_mul_f32 v52, 0x3fb8aa3b, v84
  v_mul_f32 v53, 0x3fb8aa3b, v85
  v_mul_f32 v54, 0x3fb8aa3b, v86
  v_mul_f32 v55, 0x3fb8aa3b, v87
  v_exp_f32 v48, v48
  v_exp_f32 v49, v49
  v_exp_f32 v50, v50
  v_exp_f32 v51, v51
  v_exp_f32 v52, v52
  v_exp_f32 v53, v53
  v_exp_f32 v54, v54
  v_exp_f32 v55, v55
  v_add_f32 v56, 2.0, v48
  v_add_f32 v57, 2.0, v49
  v_add_f32 v58, 2.0, v50
  v_add_f32 v59, 2.0, v51
  v_add_f32 v60, 2.0, v52
  v_add_f32 v61, 2.0, v53
  v_add_f32 v62, 2.0, v54
  v_add_f32 v63, 2.0, v55
  v_fma_f32 v56, v48, v56, 2.0
  v_fma_f32 v57, v49, v57, 2.0
  v_fma_f32 v58, v50, v58, 2.0
  v_fma_f32 v59, v51, v59, 2.0
  v_fma_f32 v60, v52, v60, 2.0
  v_fma_f32 v61, v53, v61, 2.0
  v_fma_f32 v62, v54, v62, 2.0
  v_fma_f32 v63, v55, v63, 2.0
  v_rcp_f32 v56, v56
  v_rcp_f32 v57, v57
  v_rcp_f32 v58, v58
  v_rcp_f32 v59, v59
  v_rcp_f32 v60, v60
  v_rcp_f32 v61, v61
  v_rcp_f32 v62, v62
  v_rcp_f32 v63, v63
  v_mul_f32 v56, v80, v56
  v_mul_f32 v57, v81, v57
  v_mul_f32 v58, v82, v58
  v_mul_f32 v59, v83, v59
  v_mul_f32 v60, v84, v60
  v_mul_f32 v61, v85, v61
  v_mul_f32 v62, v86, v62
  v_mul_f32 v63, v87, v63
  v_fma_f32 v80, -2.0, v56, v80
  v_fma_f32 v81, -2.0, v57, v81
  v_fma_f32 v82, -2.0, v58, v82
  v_fma_f32 v83, -2.0, v59, v83
  v_fma_f32 v84, -2.0, v60, v84
  v_fma_f32 v85, -2.0, v61, v85
  v_fma_f32 v86, -2.0, v62, v86
  v_fma_f32 v87, -2.0, v63, v87
  v_cvt_pk_bf16_f32 v44, v80, v81
  v_cvt_pk_bf16_f32 v45, v82, v83
  v_cvt_pk_bf16_f32 v46, v84, v85
  v_cvt_pk_bf16_f32 v47, v86, v87
  buffer_store_dwordx4 v[44:47], v4, s[12:15], s42 offen sc1
  s_waitcnt lgkmcnt(2)
  s_mul_i32 s41, s24, 6
  s_lshl_b32 s38, s28, 1
  s_add_u32 s41, s41, s38
  s_mul_i32 s42, s40, 90
  s_add_u32 s42, s42, s41
  s_lshl_b32 s42, s42, 10
  v_lshlrev_b32 v48, 16, v112
  v_and_b32 v49, s45, v112
  v_lshlrev_b32 v50, 16, v113
  v_and_b32 v51, s45, v113
  v_lshlrev_b32 v52, 16, v114
  v_and_b32 v53, s45, v114
  v_lshlrev_b32 v54, 16, v115
  v_and_b32 v55, s45, v115
  v_fma_f32 v48, -v22, v120, v48
  v_fma_f32 v49, -v22, v121, v49
  v_fma_f32 v50, -v22, v122, v50
  v_fma_f32 v51, -v22, v123, v51
  v_fma_f32 v52, -v22, v124, v52
  v_fma_f32 v53, -v22, v125, v53
  v_fma_f32 v54, -v22, v126, v54
  v_fma_f32 v55, -v22, v127, v55
  v_fma_f32 v88, v23, v88, v48
  v_fma_f32 v89, v23, v89, v49
  v_fma_f32 v90, v23, v90, v50
  v_fma_f32 v91, v23, v91, v51
  v_fma_f32 v92, v23, v92, v52
  v_fma_f32 v93, v23, v93, v53
  v_fma_f32 v94, v23, v94, v54
  v_fma_f32 v95, v23, v95, v55
  v_mul_f32 v48, 0x3fb8aa3b, v88
  v_mul_f32 v49, 0x3fb8aa3b, v89
  v_mul_f32 v50, 0x3fb8aa3b, v90
  v_mul_f32 v51, 0x3fb8aa3b, v91
  v_mul_f32 v52, 0x3fb8aa3b, v92
  v_mul_f32 v53, 0x3fb8aa3b, v93
  v_mul_f32 v54, 0x3fb8aa3b, v94
  v_mul_f32 v55, 0x3fb8aa3b, v95
  v_exp_f32 v48, v48
  v_exp_f32 v49, v49
  v_exp_f32 v50, v50
  v_exp_f32 v51, v51
  v_exp_f32 v52, v52
  v_exp_f32 v53, v53
  v_exp_f32 v54, v54
  v_exp_f32 v55, v55
  v_add_f32 v56, 2.0, v48
  v_add_f32 v57, 2.0, v49
  v_add_f32 v58, 2.0, v50
  v_add_f32 v59, 2.0, v51
  v_add_f32 v60, 2.0, v52
  v_add_f32 v61, 2.0, v53
  v_add_f32 v62, 2.0, v54
  v_add_f32 v63, 2.0, v55
  v_fma_f32 v56, v48, v56, 2.0
  v_fma_f32 v57, v49, v57, 2.0
  v_fma_f32 v58, v50, v58, 2.0
  v_fma_f32 v59, v51, v59, 2.0
  v_fma_f32 v60, v52, v60, 2.0
  v_fma_f32 v61, v53, v61, 2.0
  v_fma_f32 v62, v54, v62, 2.0
  v_fma_f32 v63, v55, v63, 2.0
  v_rcp_f32 v56, v56
  v_rcp_f32 v57, v57
  v_rcp_f32 v58, v58
  v_rcp_f32 v59, v59
  v_rcp_f32 v60, v60
  v_rcp_f32 v61, v61
  v_rcp_f32 v62, v62
  v_rcp_f32 v63, v63
  v_mul_f32 v56, v88, v56
  v_mul_f32 v57, v89, v57
  v_mul_f32 v58, v90, v58
  v_mul_f32 v59, v91, v59
  v_mul_f32 v60, v92, v60
  v_mul_f32 v61, v93, v61
  v_mul_f32 v62, v94, v62
  v_mul_f32 v63, v95, v63
  v_fma_f32 v88, -2.0, v56, v88
  v_fma_f32 v89, -2.0, v57, v89
  v_fma_f32 v90, -2.0, v58, v90
  v_fma_f32 v91, -2.0, v59, v91
  v_fma_f32 v92, -2.0, v60, v92
  v_fma_f32 v93, -2.0, v61, v93
  v_fma_f32 v94, -2.0, v62, v94
  v_fma_f32 v95, -2.0, v63, v95
  v_cvt_pk_bf16_f32 v40, v88, v89
  v_cvt_pk_bf16_f32 v41, v90, v91
  v_cvt_pk_bf16_f32 v42, v92, v93
  v_cvt_pk_bf16_f32 v43, v94, v95
  buffer_store_dwordx4 v[40:43], v4, s[12:15], s42 offen sc1
  s_waitcnt lgkmcnt(0)
  s_mul_i32 s41, s24, 6
  s_lshl_b32 s38, s28, 1
  s_add_u32 s41, s41, s38
  s_add_u32 s41, s41, 1
  s_mul_i32 s42, s40, 90
  s_add_u32 s42, s42, s41
  s_lshl_b32 s42, s42, 10
  v_lshlrev_b32 v48, 16, v116
  v_and_b32 v49, s45, v116
  v_lshlrev_b32 v50, 16, v117
  v_and_b32 v51, s45, v117
  v_lshlrev_b32 v52, 16, v118
  v_and_b32 v53, s45, v118
  v_lshlrev_b32 v54, 16, v119
  v_and_b32 v55, s45, v119
  v_fma_f32 v48, -v22, v26, v48
  v_fma_f32 v49, -v22, v27, v49
  v_fma_f32 v50, -v22, v28, v50
  v_fma_f32 v51, -v22, v29, v51
  v_fma_f32 v52, -v22, v30, v52
  v_fma_f32 v53, -v22, v31, v53
  v_fma_f32 v54, -v22, v32, v54
  v_fma_f32 v55, -v22, v33, v55
  v_fma_f32 v96, v23, v96, v48
  v_fma_f32 v97, v23, v97, v49
  v_fma_f32 v98, v23, v98, v50
  v_fma_f32 v99, v23, v99, v51
  v_fma_f32 v100, v23, v100, v52
  v_fma_f32 v101, v23, v101, v53
  v_fma_f32 v102, v23, v102, v54
  v_fma_f32 v103, v23, v103, v55
  v_mul_f32 v48, 0x3fb8aa3b, v96
  v_mul_f32 v49, 0x3fb8aa3b, v97
  v_mul_f32 v50, 0x3fb8aa3b, v98
  v_mul_f32 v51, 0x3fb8aa3b, v99
  v_mul_f32 v52, 0x3fb8aa3b, v100
  v_mul_f32 v53, 0x3fb8aa3b, v101
  v_mul_f32 v54, 0x3fb8aa3b, v102
  v_mul_f32 v55, 0x3fb8aa3b, v103
  v_exp_f32 v48, v48
  v_exp_f32 v49, v49
  v_exp_f32 v50, v50
  v_exp_f32 v51, v51
  v_exp_f32 v52, v52
  v_exp_f32 v53, v53
  v_exp_f32 v54, v54
  v_exp_f32 v55, v55
  v_add_f32 v56, 2.0, v48
  v_add_f32 v57, 2.0, v49
  v_add_f32 v58, 2.0, v50
  v_add_f32 v59, 2.0, v51
  v_add_f32 v60, 2.0, v52
  v_add_f32 v61, 2.0, v53
  v_add_f32 v62, 2.0, v54
  v_add_f32 v63, 2.0, v55
  v_fma_f32 v56, v48, v56, 2.0
  v_fma_f32 v57, v49, v57, 2.0
  v_fma_f32 v58, v50, v58, 2.0
  v_fma_f32 v59, v51, v59, 2.0
  v_fma_f32 v60, v52, v60, 2.0
  v_fma_f32 v61, v53, v61, 2.0
  v_fma_f32 v62, v54, v62, 2.0
  v_fma_f32 v63, v55, v63, 2.0
  v_rcp_f32 v56, v56
  v_rcp_f32 v57, v57
  v_rcp_f32 v58, v58
  v_rcp_f32 v59, v59
  v_rcp_f32 v60, v60
  v_rcp_f32 v61, v61
  v_rcp_f32 v62, v62
  v_rcp_f32 v63, v63
  v_mul_f32 v56, v96, v56
  v_mul_f32 v57, v97, v57
  v_mul_f32 v58, v98, v58
  v_mul_f32 v59, v99, v59
  v_mul_f32 v60, v100, v60
  v_mul_f32 v61, v101, v61
  v_mul_f32 v62, v102, v62
  v_mul_f32 v63, v103, v63
  v_fma_f32 v96, -2.0, v56, v96
  v_fma_f32 v97, -2.0, v57, v97
  v_fma_f32 v98, -2.0, v58, v98
  v_fma_f32 v99, -2.0, v59, v99
  v_fma_f32 v100, -2.0, v60, v100
  v_fma_f32 v101, -2.0, v61, v101
  v_fma_f32 v102, -2.0, v62, v102
  v_fma_f32 v103, -2.0, v63, v103
  v_cvt_pk_bf16_f32 v44, v96, v97
  v_cvt_pk_bf16_f32 v45, v98, v99
  v_cvt_pk_bf16_f32 v46, v100, v101
  v_cvt_pk_bf16_f32 v47, v102, v103
  buffer_store_dwordx4 v[44:47], v4, s[12:15], s42 offen sc1
  s_branch L_k4_ffn1_kernel_join
L_k4_ffn1_kernel_roleB:
  s_mul_i32 s38, s24, 192
  v_lshlrev_b32 v5, 3, v3
  v_add_u32 v5, s38, v5
  s_lshl_b32 s38, s29, 6
  buffer_load_dwordx2 v[104:105], v5, s[16:19], s38 offen offset:0
  buffer_load_dwordx2 v[106:107], v5, s[16:19], s38 offen offset:16
  buffer_load_dwordx2 v[108:109], v5, s[16:19], s38 offen offset:32
  buffer_load_dwordx2 v[110:111], v5, s[16:19], s38 offen offset:48
  s_waitcnt vmcnt(8)
  s_barrier
  ds_read_b128 v[40:43], v26 offset:0
  ds_read_b64_tr_b16 v[48:49], v22 offset:0
  ds_read_b64_tr_b16 v[50:51], v22 offset:1536
  ds_read_b128 v[44:47], v26 offset:1024
  ds_read_b64_tr_b16 v[56:57], v22 offset:3072
  ds_read_b64_tr_b16 v[58:59], v22 offset:4608
  s_waitcnt lgkmcnt(3)
  v_mfma_f32_32x32x16_bf16 v[72:87], v[48:51], v[40:43], v[72:87]
  s_add_u32 m0, s25, 57344
  s_movk_i32 s38, 8192
  buffer_load_dwordx4 v10, s[4:7], s38 offen offset:0 lds
  s_add_u32 m0, s25, 57344
  s_movk_i32 s38, 8192
  buffer_load_dwordx4 v10, s[4:7], s38 offen offset:1024 lds
  ds_read_b128 v[40:43], v26 offset:2048
  ds_read_b64_tr_b16 v[48:49], v22 offset:6144
  ds_read_b64_tr_b16 v[50:51], v22 offset:7680
  s_waitcnt lgkmcnt(3)
  v_mfma_f32_32x32x16_bf16 v[72:87], v[56:59], v[44:47], v[72:87]
  s_add_u32 m0, s26, 57344
  s_mov_b32 s38, 352256
  s_mov_b64 exec, s[46:47]
  buffer_load_dwordx4 v14, s[8:11], s38 offen lds
  s_mov_b64 exec, -1
  ds_read_b128 v[44:47], v26 offset:3072
  ds_read_b64_tr_b16 v[56:57], v22 offset:9216
  ds_read_b64_tr_b16 v[58:59], v22 offset:10752
  s_waitcnt lgkmcnt(3)
  v_mfma_f32_32x32x16_bf16 v[72:87], v[48:51], v[40:43], v[72:87]
  s_add_u32 m0, s26, 58112
  s_mov_b32 s38, 363264
  s_mov_b64 exec, s[46:47]
  buffer_load_dwordx4 v14, s[8:11], s38 offen lds
  s_mov_b64 exec, -1
  s_waitcnt vmcnt(10)
  s_barrier
  ds_read_b128 v[40:43], v26 offset:28672
  ds_read_b64_tr_b16 v[48:49], v22 offset:28672
  ds_read_b64_tr_b16 v[50:51], v22 offset:30208
  s_waitcnt lgkmcnt(3)
  v_mfma_f32_32x32x16_bf16 v[72:87], v[56:59], v[44:47], v[72:87]
  s_add_u32 m0, s25, 86016
  s_movk_i32 s38, 12288
  buffer_load_dwordx4 v10, s[4:7], s38 offen offset:0 lds
  ds_read_b128 v[44:47], v26 offset:29696
  ds_read_b64_tr_b16 v[56:57], v22 offset:31744
  ds_read_b64_tr_b16 v[58:59], v22 offset:33280
  s_waitcnt lgkmcnt(3)
  v_mfma_f32_32x32x16_bf16 v[72:87], v[48:51], v[40:43], v[72:87]
  s_add_u32 m0, s25, 86016
  s_movk_i32 s38, 12288
  buffer_load_dwordx4 v10, s[4:7], s38 offen offset:1024 lds
  ds_read_b128 v[40:43], v26 offset:30720
  ds_read_b64_tr_b16 v[48:49], v22 offset:34816
  ds_read_b64_tr_b16 v[50:51], v22 offset:36352
  s_waitcnt lgkmcnt(3)
  v_mfma_f32_32x32x16_bf16 v[72:87], v[56:59], v[44:47], v[72:87]
  s_add_u32 m0, s26, 86016
  s_mov_b32 s38, 528384
  s_mov_b64 exec, s[46:47]
  buffer_load_dwordx4 v14, s[8:11], s38 offen lds
  s_mov_b64 exec, -1
  ds_read_b128 v[44:47], v26 offset:31744
  ds_read_b64_tr_b16 v[56:57], v22 offset:37888
  ds_read_b64_tr_b16 v[58:59], v22 offset:39424
  s_waitcnt lgkmcnt(3)
  v_mfma_f32_32x32x16_bf16 v[72:87], v[48:51], v[40:43], v[72:87]
  s_add_u32 m0, s26, 86784
  s_mov_b32 s38, 539392
  s_mov_b64 exec, s[46:47]
  buffer_load_dwordx4 v14, s[8:11], s38 offen lds
  s_mov_b64 exec, -1
  s_waitcnt vmcnt(4)
  s_barrier
  ds_read_b128 v[40:43], v27 offset:0
  ds_read_b64_tr_b16 v[48:49], v25 offset:0
  ds_read_b64_tr_b16 v[50:51], v25 offset:1536
  s_waitcnt lgkmcnt(3)
  v_mfma_f32_32x32x16_bf16 v[72:87], v[56:59], v[44:47], v[72:87]
  s_add_u32 m0, s25, 0
  s_movk_i32 s38, 16384
  buffer_load_dwordx4 v10, s[4:7], s38 offen offset:0 lds
  ds_read_b128 v[44:47], v27 offset:1024
  ds_read_b64_tr_b16 v[56:57], v25 offset:3072
  ds_read_b64_tr_b16 v[58:59], v25 offset:4608
  s_waitcnt lgkmcnt(3)
  v_mfma_f32_32x32x16_bf16 v[72:87], v[48:51], v[40:43], v[72:87]
  s_add_u32 m0, s25, 0
  s_movk_i32 s38, 16384
  buffer_load_dwordx4 v10, s[4:7], s38 offen offset:1024 lds
  ds_read_b128 v[40:43], v27 offset:2048
  ds_read_b64_tr_b16 v[48:49], v25 offset:6144
  ds_read_b64_tr_b16 v[50:51], v25 offset:7680
  s_waitcnt lgkmcnt(3)
  v_mfma_f32_32x32x16_bf16 v[72:87], v[56:59], v[44:47], v[72:87]
  s_add_u32 m0, s26, 0
  s_mov_b32 s38, 704512
  s_mov_b64 exec, s[46:47]
  buffer_load_dwordx4 v14, s[8:11], s38 offen lds
  s_mov_b64 exec, -1
  ds_read_b128 v[44:47], v27 offset:3072
  ds_read_b64_tr_b16 v[56:57], v25 offset:9216
  ds_read_b64_tr_b16 v[58:59], v25 offset:10752
  s_waitcnt lgkmcnt(3)
  v_mfma_f32_32x32x16_bf16 v[72:87], v[48:51], v[40:43], v[72:87]
  s_add_u32 m0, s26, 768
  s_mov_b32 s38, 715520
  s_mov_b64 exec, s[46:47]
  buffer_load_dwordx4 v14, s[8:11], s38 offen lds
  s_mov_b64 exec, -1
  s_waitcnt vmcnt(4)
  s_barrier
  ds_read_b128 v[40:43], v27 offset:28672
  ds_read_b64_tr_b16 v[48:49], v25 offset:28672
  ds_read_b64_tr_b16 v[50:51], v25 offset:30208
  s_waitcnt lgkmcnt(3)
  v_mfma_f32_32x32x16_bf16 v[72:87], v[56:59], v[44:47], v[72:87]
  s_add_u32 m0, s25, 28672
  s_movk_i32 s38, 20480
  buffer_load_dwordx4 v10, s[4:7], s38 offen offset:0 lds
  ds_read_b128 v[44:47], v27 offset:29696
  ds_read_b64_tr_b16 v[56:57], v25 offset:31744
  ds_read_b64_tr_b16 v[58:59], v25 offset:33280
  s_waitcnt lgkmcnt(3)
  v_mfma_f32_32x32x16_bf16 v[72:87], v[48:51], v[40:43], v[72:87]
  s_add_u32 m0, s25, 28672
  s_movk_i32 s38, 20480
  buffer_load_dwordx4 v10, s[4:7], s38 offen offset:1024 lds
  ds_read_b128 v[40:43], v27 offset:30720
  ds_read_b64_tr_b16 v[48:49], v25 offset:34816
  ds_read_b64_tr_b16 v[50:51], v25 offset:36352
  s_waitcnt lgkmcnt(3)
  v_mfma_f32_32x32x16_bf16 v[72:87], v[56:59], v[44:47], v[72:87]
  s_add_u32 m0, s26, 28672
  s_mov_b32 s38, 880640
  s_mov_b64 exec, s[46:47]
  buffer_load_dwordx4 v14, s[8:11], s38 offen lds
  s_mov_b64 exec, -1
  ds_read_b128 v[44:47], v27 offset:31744
  ds_read_b64_tr_b16 v[56:57], v25 offset:37888
  ds_read_b64_tr_b16 v[58:59], v25 offset:39424
  s_waitcnt lgkmcnt(3)
  v_mfma_f32_32x32x16_bf16 v[72:87], v[48:51], v[40:43], v[72:87]
  s_add_u32 m0, s26, 29440
  s_mov_b32 s38, 891648
  s_mov_b64 exec, s[46:47]
  buffer_load_dwordx4 v14, s[8:11], s38 offen lds
  s_mov_b64 exec, -1
  s_waitcnt vmcnt(4)
  s_barrier
  ds_read_b128 v[40:43], v26 offset:0
  ds_read_b64_tr_b16 v[48:49], v22 offset:0
  ds_read_b64_tr_b16 v[50:51], v22 offset:1536
  s_waitcnt lgkmcnt(3)
  v_mfma_f32_32x32x16_bf16 v[72:87], v[56:59], v[44:47], v[72:87]
  s_add_u32 m0, s25, 57344
  s_movk_i32 s38, 24576
  buffer_load_dwordx4 v10, s[4:7], s38 offen offset:0 lds
  ds_read_b128 v[44:47], v26 offset:1024
  ds_read_b64_tr_b16 v[56:57], v22 offset:3072
  ds_read_b64_tr_b16 v[58:59], v22 offset:4608
  s_waitcnt lgkmcnt(3)
  v_mfma_f32_32x32x16_bf16 v[72:87], v[48:51], v[40:43], v[72:87]
  s_add_u32 m0, s25, 57344
  s_movk_i32 s38, 24576
  buffer_load_dwordx4 v10, s[4:7], s38 offen offset:1024 lds
  ds_read_b128 v[40:43], v26 offset:2048
  ds_read_b64_tr_b16 v[48:49], v22 offset:6144
  ds_read_b64_tr_b16 v[50:51], v22 offset:7680
  s_waitcnt lgkmcnt(3)
  v_mfma_f32_32x32x16_bf16 v[72:87], v[56:59], v[44:47], v[72:87]
  s_add_u32 m0, s26, 57344
  s_mov_b32 s38, 1056768
  s_mov_b64 exec, s[46:47]
  buffer_load_dwordx4 v14, s[8:11], s38 offen lds
  s_mov_b64 exec, -1
  ds_read_b128 v[44:47], v26 offset:3072
  ds_read_b64_tr_b16 v[56:57], v22 offset:9216
  ds_read_b64_tr_b16 v[58:59], v22 offset:10752
  s_waitcnt lgkmcnt(3)
  v_mfma_f32_32x32x16_bf16 v[72:87], v[48:51], v[40:43], v[72:87]
  s_add_u32 m0, s26, 58112
  s_mov_b32 s38, 1067776
  s_mov_b64 exec, s[46:47]
  buffer_load_dwordx4 v14, s[8:11], s38 offen lds
  s_mov_b64 exec, -1
  s_waitcnt vmcnt(4)
  s_barrier
  ds_read_b128 v[40:43], v26 offset:28672
  ds_read_b64_tr_b16 v[48:49], v22 offset:28672
  ds_read_b64_tr_b16 v[50:51], v22 offset:30208
  s_waitcnt lgkmcnt(3)
  v_mfma_f32_32x32x16_bf16 v[72:87], v[56:59], v[44:47], v[72:87]
  s_add_u32 m0, s25, 86016
  s_movk_i32 s38, 28672
  buffer_load_dwordx4 v10, s[4:7], s38 offen offset:0 lds
  ds_read_b128 v[44:47], v26 offset:29696
  ds_read_b64_tr_b16 v[56:57], v22 offset:31744
  ds_read_b64_tr_b16 v[58:59], v22 offset:33280
  s_waitcnt lgkmcnt(3)
  v_mfma_f32_32x32x16_bf16 v[72:87], v[48:51], v[40:43], v[72:87]
  s_add_u32 m0, s25, 86016
  s_movk_i32 s38, 28672
  buffer_load_dwordx4 v10, s[4:7], s38 offen offset:1024 lds
  ds_read_b128 v[40:43], v26 offset:30720
  ds_read_b64_tr_b16 v[48:49], v22 offset:34816
  ds_read_b64_tr_b16 v[50:51], v22 offset:36352
  s_waitcnt lgkmcnt(3)
  v_mfma_f32_32x32x16_bf16 v[72:87], v[56:59], v[44:47], v[72:87]
  s_add_u32 m0, s26, 86016
  s_mov_b32 s38, 1232896
  s_mov_b64 exec, s[46:47]
  buffer_load_dwordx4 v14, s[8:11], s38 offen lds
  s_mov_b64 exec, -1
  ds_read_b128 v[44:47], v26 offset:31744
  ds_read_b64_tr_b16 v[56:57], v22 offset:37888
  ds_read_b64_tr_b16 v[58:59], v22 offset:39424
  s_waitcnt lgkmcnt(3)
  v_mfma_f32_32x32x16_bf16 v[72:87], v[48:51], v[40:43], v[72:87]
  s_add_u32 m0, s26, 86784
  s_mov_b32 s38, 1243904
  s_mov_b64 exec, s[46:47]
  buffer_load_dwordx4 v14, s[8:11], s38 offen lds
  s_mov_b64 exec, -1
  s_waitcnt vmcnt(4)
  s_barrier
  ds_read_b128 v[40:43], v27 offset:0
  ds_read_b64_tr_b16 v[48:49], v25 offset:0
  ds_read_b64_tr_b16 v[50:51], v25 offset:1536
  s_waitcnt lgkmcnt(3)
  v_mfma_f32_32x32x16_bf16 v[72:87], v[56:59], v[44:47], v[72:87]
  ds_read_b128 v[44:47], v27 offset:1024
  ds_read_b64_tr_b16 v[56:57], v25 offset:3072
  ds_read_b64_tr_b16 v[58:59], v25 offset:4608
  s_waitcnt lgkmcnt(3)
  v_mfma_f32_32x32x16_bf16 v[72:87], v[48:51], v[40:43], v[72:87]
  ds_read_b128 v[40:43], v27 offset:2048
  ds_read_b64_tr_b16 v[48:49], v25 offset:6144
  ds_read_b64_tr_b16 v[50:51], v25 offset:7680
  s_waitcnt lgkmcnt(3)
  v_mfma_f32_32x32x16_bf16 v[72:87], v[56:59], v[44:47], v[72:87]
  ds_read_b128 v[44:47], v27 offset:3072
  ds_read_b64_tr_b16 v[56:57], v25 offset:9216
  ds_read_b64_tr_b16 v[58:59], v25 offset:10752
  s_waitcnt lgkmcnt(3)
  v_mfma_f32_32x32x16_bf16 v[72:87], v[48:51], v[40:43], v[72:87]
  s_waitcnt vmcnt(0)
  s_barrier
  ds_read_b128 v[40:43], v27 offset:28672
  ds_read_b64_tr_b16 v[48:49], v25 offset:28672
  ds_read_b64_tr_b16 v[50:51], v25 offset:30208
  s_waitcnt lgkmcnt(3)
  v_mfma_f32_32x32x16_bf16 v[72:87], v[56:59], v[44:47], v[72:87]
  ds_read_b128 v[44:47], v27 offset:29696
  ds_read_b64_tr_b16 v[56:57], v25 offset:31744
  ds_read_b64_tr_b16 v[58:59], v25 offset:33280
  s_waitcnt lgkmcnt(3)
  v_mfma_f32_32x32x16_bf16 v[72:87], v[48:51], v[40:43], v[72:87]
  ds_read_b128 v[40:43], v27 offset:30720
  ds_read_b64_tr_b16 v[48:49], v25 offset:34816
  ds_read_b64_tr_b16 v[50:51], v25 offset:36352
  s_waitcnt lgkmcnt(3)
  v_mfma_f32_32x32x16_bf16 v[72:87], v[56:59], v[44:47], v[72:87]
  ds_read_b128 v[44:47], v27 offset:31744
  ds_read_b64_tr_b16 v[56:57], v25 offset:37888
  ds_read_b64_tr_b16 v[58:59], v25 offset:39424
  s_waitcnt lgkmcnt(3)
  v_mfma_f32_32x32x16_bf16 v[72:87], v[48:51], v[40:43], v[72:87]
  s_waitcnt lgkmcnt(0)
  v_mfma_f32_32x32x16_bf16 v[72:87], v[56:59], v[44:47], v[72:87]
  s_lshl_b32 s38, s21, 8
  v_lshlrev_b32 v7, 3, v2
  v_add_u32 v7, s38, v7
  v_add_f32 v8, v120, v122
  v_add_f32 v9, v121, v123
  v_add_f32 v12, v124, v126
  v_add_f32 v13, v125, v127
  v_add_f32 v8, v8, v12
  v_add_f32 v9, v9, v13
  v_mov_b32 v12, v8
  v_mov_b32 v13, v9
  s_nop 1
  v_permlane32_swap_b32 v8, v12
  v_permlane32_swap_b32 v9, v13
  s_nop 1
  v_add_f32 v8, v8, v12
  v_add_f32 v9, v9, v13
  v_mul_f32 v22, 0x3b000000, v8
  v_mul_f32 v23, 0x3b000000, v9
  v_fma_f32 v23, -v22, v22, v23
  v_max_f32 v23, 0, v23
  v_add_f32 v23, 0x3727c5ac, v23
  v_rsq_f32 v23, v23
  s_nop 0
  v_mul_f32 v22, v22, v23
  v_lshlrev_b32 v10, 4, v3
  v_lshlrev_b32 v15, 5, v2
  v_add_u32 v15, v15, v10
  s_lshl_b32 s38, s29, 7
  v_add_u32 v16, s38, v10
  s_waitcnt lgkmcnt(0)
  s_barrier
  ds_read_b128 v[120:123], v16 offset:4096
  ds_read_b128 v[124:127], v16 offset:4128
  ds_read_b128 v[26:29], v16 offset:4160
  ds_read_b128 v[30:33], v16 offset:4192
  s_waitcnt lgkmcnt(2)
  s_mul_i32 s41, s24, 6
  s_lshl_b32 s38, s29, 1
  s_add_u32 s41, s41, s38
  s_mul_i32 s42, s40, 90
  s_add_u32 s42, s42, s41
  s_lshl_b32 s42, s42, 10
  v_lshlrev_b32 v48, 16, v104
  v_and_b32 v49, s45, v104
  v_lshlrev_b32 v50, 16, v105
  v_and_b32 v51, s45, v105
  v_lshlrev_b32 v52, 16, v106
  v_and_b32 v53, s45, v106
  v_lshlrev_b32 v54, 16, v107
  v_and_b32 v55, s45, v107
  v_fma_f32 v48, -v22, v120, v48
  v_fma_f32 v49, -v22, v121, v49
  v_fma_f32 v50, -v22, v122, v50
  v_fma_f32 v51, -v22, v123, v51
  v_fma_f32 v52, -v22, v124, v52
  v_fma_f32 v53, -v22, v125, v53
  v_fma_f32 v54, -v22, v126, v54
  v_fma_f32 v55, -v22, v127, v55
  v_fma_f32 v72, v23, v72, v48
  v_fma_f32 v73, v23, v73, v49
  v_fma_f32 v74, v23, v74, v50
  v_fma_f32 v75, v23, v75, v51
  v_fma_f32 v76, v23, v76, v52
  v_fma_f32 v77, v23, v77, v53
  v_fma_f32 v78, v23, v78, v54
  v_fma_f32 v79, v23, v79, v55
  v_mul_f32 v48, 0x3fb8aa3b, v72
  v_mul_f32 v49, 0x3fb8aa3b, v73
  v_mul_f32 v50, 0x3fb8aa3b, v74
  v_mul_f32 v51, 0x3fb8aa3b, v75
  v_mul_f32 v52, 0x3fb8aa3b, v76
  v_mul_f32 v53, 0x3fb8aa3b, v77
  v_mul_f32 v54, 0x3fb8aa3b, v78
  v_mul_f32 v55, 0x3fb8aa3b, v79
  v_exp_f32 v48, v48
  v_exp_f32 v49, v49
  v_exp_f32 v50, v50
  v_exp_f32 v51, v51
  v_exp_f32 v52, v52
  v_exp_f32 v53, v53
  v_exp_f32 v54, v54
  v_exp_f32 v55, v55
  v_add_f32 v56, 2.0, v48
  v_add_f32 v57, 2.0, v49
  v_add_f32 v58, 2.0, v50
  v_add_f32 v59, 2.0, v51
  v_add_f32 v60, 2.0, v52
  v_add_f32 v61, 2.0, v53
  v_add_f32 v62, 2.0, v54
  v_add_f32 v63, 2.0, v55
  v_fma_f32 v56, v48, v56, 2.0
  v_fma_f32 v57, v49, v57, 2.0
  v_fma_f32 v58, v50, v58, 2.0
  v_fma_f32 v59, v51, v59, 2.0
  v_fma_f32 v60, v52, v60, 2.0
  v_fma_f32 v61, v53, v61, 2.0
  v_fma_f32 v62, v54, v62, 2.0
  v_fma_f32 v63, v55, v63, 2.0
  v_rcp_f32 v56, v56
  v_rcp_f32 v57, v57
  v_rcp_f32 v58, v58
  v_rcp_f32 v59, v59
  v_rcp_f32 v60, v60
  v_rcp_f32 v61, v61
  v_rcp_f32 v62, v62
  v_rcp_f32 v63, v63
  v_mul_f32 v56, v72, v56
  v_mul_f32 v57, v73, v57
  v_mul_f32 v58, v74, v58
  v_mul_f32 v59, v75, v59
  v_mul_f32 v60, v76, v60
  v_mul_f32 v61, v77, v61
  v_mul_f32 v62, v78, v62
  v_mul_f32 v63, v79, v63
  v_fma_f32 v72, -2.0, v56, v72
  v_fma_f32 v73, -2.0, v57, v73
  v_fma_f32 v74, -2.0, v58, v74
  v_fma_f32 v75, -2.0, v59, v75
  v_fma_f32 v76, -2.0, v60, v76
  v_fma_f32 v77, -2.0, v61, v77
  v_fma_f32 v78, -2.0, v62, v78
  v_fma_f32 v79, -2.0, v63, v79
  v_cvt_pk_bf16_f32 v40, v72, v73
  v_cvt_pk_bf16_f32 v41, v74, v75
  v_cvt_pk_bf16_f32 v42, v76, v77
  v_cvt_pk_bf16_f32 v43, v78, v79
  buffer_store_dwordx4 v[40:43], v4, s[12:15], s42 offen sc1
  s_waitcnt lgkmcnt(0)
  s_mul_i32 s41, s24, 6
  s_lshl_b32 s38, s29, 1
  s_add_u32 s41, s41, s38
  s_add_u32 s41, s41, 1
  s_mul_i32 s42, s40, 90
  s_add_u32 s42, s42, s41
  s_lshl_b32 s42, s42, 10
  v_lshlrev_b32 v48, 16, v108
  v_and_b32 v49, s45, v108
  v_lshlrev_b32 v50, 16, v109
  v_and_b32 v51, s45, v109
  v_lshlrev_b32 v52, 16, v110
  v_and_b32 v53, s45, v110
  v_lshlrev_b32 v54, 16, v111
  v_and_b32 v55, s45, v111
  v_fma_f32 v48, -v22, v26, v48
  v_fma_f32 v49, -v22, v27, v49
  v_fma_f32 v50, -v22, v28, v50
  v_fma_f32 v51, -v22, v29, v51
  v_fma_f32 v52, -v22, v30, v52
  v_fma_f32 v53, -v22, v31, v53
  v_fma_f32 v54, -v22, v32, v54
  v_fma_f32 v55, -v22, v33, v55
  v_fma_f32 v80, v23, v80, v48
  v_fma_f32 v81, v23, v81, v49
  v_fma_f32 v82, v23, v82, v50
  v_fma_f32 v83, v23, v83, v51
  v_fma_f32 v84, v23, v84, v52
  v_fma_f32 v85, v23, v85, v53
  v_fma_f32 v86, v23, v86, v54
  v_fma_f32 v87, v23, v87, v55
  v_mul_f32 v48, 0x3fb8aa3b, v80
  v_mul_f32 v49, 0x3fb8aa3b, v81
  v_mul_f32 v50, 0x3fb8aa3b, v82
  v_mul_f32 v51, 0x3fb8aa3b, v83
  v_mul_f32 v52, 0x3fb8aa3b, v84
  v_mul_f32 v53, 0x3fb8aa3b, v85
  v_mul_f32 v54, 0x3fb8aa3b, v86
  v_mul_f32 v55, 0x3fb8aa3b, v87
  v_exp_f32 v48, v48
  v_exp_f32 v49, v49
  v_exp_f32 v50, v50
  v_exp_f32 v51, v51
  v_exp_f32 v52, v52
  v_exp_f32 v53, v53
  v_exp_f32 v54, v54
  v_exp_f32 v55, v55
  v_add_f32 v56, 2.0, v48
  v_add_f32 v57, 2.0, v49
  v_add_f32 v58, 2.0, v50
  v_add_f32 v59, 2.0, v51
  v_add_f32 v60, 2.0, v52
  v_add_f32 v61, 2.0, v53
  v_add_f32 v62, 2.0, v54
  v_add_f32 v63, 2.0, v55
  v_fma_f32 v56, v48, v56, 2.0
  v_fma_f32 v57, v49, v57, 2.0
  v_fma_f32 v58, v50, v58, 2.0
  v_fma_f32 v59, v51, v59, 2.0
  v_fma_f32 v60, v52, v60, 2.0
  v_fma_f32 v61, v53, v61, 2.0
  v_fma_f32 v62, v54, v62, 2.0
  v_fma_f32 v63, v55, v63, 2.0
  v_rcp_f32 v56, v56
  v_rcp_f32 v57, v57
  v_rcp_f32 v58, v58
  v_rcp_f32 v59, v59
  v_rcp_f32 v60, v60
  v_rcp_f32 v61, v61
  v_rcp_f32 v62, v62
  v_rcp_f32 v63, v63
  v_mul_f32 v56, v80, v56
  v_mul_f32 v57, v81, v57
  v_mul_f32 v58, v82, v58
  v_mul_f32 v59, v83, v59
  v_mul_f32 v60, v84, v60
  v_mul_f32 v61, v85, v61
  v_mul_f32 v62, v86, v62
  v_mul_f32 v63, v87, v63
  v_fma_f32 v80, -2.0, v56, v80
  v_fma_f32 v81, -2.0, v57, v81
  v_fma_f32 v82, -2.0, v58, v82
  v_fma_f32 v83, -2.0, v59, v83
  v_fma_f32 v84, -2.0, v60, v84
  v_fma_f32 v85, -2.0, v61, v85
  v_fma_f32 v86, -2.0, v62, v86
  v_fma_f32 v87, -2.0, v63, v87
  v_cvt_pk_bf16_f32 v44, v80, v81
  v_cvt_pk_bf16_f32 v45, v82, v83
  v_cvt_pk_bf16_f32 v46, v84, v85
  v_cvt_pk_bf16_f32 v47, v86, v87
  buffer_store_dwordx4 v[44:47], v4, s[12:15], s42 offen sc1
L_k4_ffn1_kernel_join:
  s_waitcnt vmcnt(0)
  s_barrier
  s_cmp_eq_u32 s20, 0
  s_cbranch_scc0 L_sig_c4
  s_lshl_b32 s56, s23, 7
  s_add_u32 s56, s56, 2048
  v_mov_b32 v5, 0
  v_mov_b32 v6, 1
  s_mov_b64 exec, 1
  buffer_atomic_add v6, v5, s[52:55], s56 offen sc1
  s_mov_b64 exec, -1
L_sig_c4:
L_k4_ffn1_kernel_end:
  s_load_dwordx2 s[30:31], s[0:1], 72
  s_load_dwordx2 s[32:33], s[0:1], 48
  s_load_dwordx2 s[34:35], s[0:1], 56
  s_and_b32 s3, s2, 7
  s_lshr_b32 s38, s2, 3
  s_lshl_b32 s23, s3, 2
  s_and_b32 s39, s38, 3
  s_add_u32 s23, s23, s39
  s_lshr_b32 s24, s38, 2
  v_and_b32 v1, 63, v0
  v_lshrrev_b32 v2, 6, v0
  s_nop 0
  v_readfirstlane_b32 s20, v2
  s_nop 3
  s_and_b32 s21, s20, 1
  s_lshr_b32 s22, s20, 2
  s_lshr_b32 s25, s20, 1
  s_and_b32 s25, s25, 1
  v_and_b32 v2, 31, v1
  v_lshrrev_b32 v3, 5, v1
  s_lshl_b32 s38, s23, 1
  s_mul_i32 s38, s38, 90
  s_add_u32 s38, s38, s20
  s_lshl_b32 s38, s38, 10
  v_lshlrev_b32 v4, 4, v1
  v_add_u32 v10, s38, v4
  v_add_u32 v11, 92160, v10
  v_lshrrev_b32 v5, 3, v1
  s_lshl_b32 s38, s20, 4
  v_add_u32 v5, s38, v5
  v_lshlrev_b32 v5, 10, v5
  v_lshrrev_b32 v6, 4, v1
  v_and_b32 v6, 1, v6
  v_lshlrev_b32 v6, 2, v6
  v_and_b32 v7, 7, v1
  v_xor_b32 v6, v6, v7
  v_lshlrev_b32 v6, 4, v6
  v_add_u32 v5, v5, v6
  s_lshl_b32 s38, s24, 7
  v_add_u32 v12, s38, v5
  s_lshl_b32 s40, s23, 1
  s_add_u32 s40, s40, s21
  s_lshl_b32 s41, s24, 2
  s_lshl_b32 s38, s25, 1
  s_add_u32 s41, s41, s38
  s_add_u32 s41, s41, s22
  s_lshl_b32 s42, s40, 5
  s_add_u32 s42, s42, s41
  s_lshl_b32 s42, s42, 10
  s_lshl_b32 s43, s40, 15
  s_lshl_b32 s38, s41, 5
  s_add_u32 s43, s43, s38
  v_lshlrev_b32 v8, 10, v2
  s_waitcnt lgkmcnt(0)
  s_add_u32 s4, s30, 10485760
  s_addc_u32 s5, s31, 0
  s_mov_b32 s6, 5898240
  s_mov_b32 s7, 0x00020000
  s_mov_b32 s12, s34
  s_mov_b32 s13, s35
  s_mov_b32 s14, 2097152
  s_mov_b32 s15, 0x00020000
  s_add_u32 s16, s30, 8388608
  s_addc_u32 s17, s31, 0
  s_mov_b32 s18, 2097152
  s_mov_b32 s19, 0x00020000
  s_mov_b32 s8, s32
  s_mov_b32 s9, s33
  s_mov_b32 s10, 1409024
  s_mov_b32 s11, 0x00020000
  buffer_load_dwordx4 v[28:31], v4, s[16:19], s42 offen
  s_lshl_b32 s26, s20, 11
  s_add_u32 s52, s30, 17825792
  s_addc_u32 s53, s31, 0
  s_mov_b32 s54, 8192
  s_mov_b32 s55, 0x00020000
  s_add_u32 m0, s26, 16384
  s_mov_b32 s38, 0
  buffer_load_dwordx4 v12, s[8:11], s38 offen lds
  s_add_u32 m0, s26, 17408
  s_mov_b32 s38, 8192
  buffer_load_dwordx4 v12, s[8:11], s38 offen lds
  s_add_u32 m0, s26, 49152
  s_mov_b32 s38, 131072
  buffer_load_dwordx4 v12, s[8:11], s38 offen lds
  s_add_u32 m0, s26, 50176
  s_mov_b32 s38, 139264
  buffer_load_dwordx4 v12, s[8:11], s38 offen lds
  s_add_u32 m0, s26, 81920
  s_mov_b32 s38, 262144
  buffer_load_dwordx4 v12, s[8:11], s38 offen lds
  s_add_u32 m0, s26, 82944
  s_mov_b32 s38, 270336
  buffer_load_dwordx4 v12, s[8:11], s38 offen lds
  s_lshr_b32 s39, s23, 1
  s_cmp_eq_u32 s20, 0
  s_cbranch_scc0 L_wt_c4
  s_lshl_b32 s56, s39, 7
  s_add_u32 s56, s56, 2048
  v_mov_b32 v5, 0
  s_mov_b32 s57, 0
L_spin_c4:
  s_sleep 10
  buffer_load_dword v6, v5, s[52:55], s56 offen sc1
  s_add_u32 s57, s57, 1
  s_waitcnt vmcnt(0)
  v_readfirstlane_b32 s38, v6
  s_cmp_ge_u32 s57, 40000
  s_cbranch_scc1 L_wt_c4
  s_cmp_lt_u32 s38, 15
  s_cbranch_scc1 L_spin_c4
L_wt_c4:
  s_barrier
  s_add_u32 m0, s26, 0
  s_movk_i32 s38, 0
  buffer_load_dwordx4 v10, s[4:7], s38 offen lds
  s_add_u32 m0, s26, 1024
  s_movk_i32 s38, 0
  buffer_load_dwordx4 v11, s[4:7], s38 offen lds
  s_add_u32 m0, s26, 32768
  s_movk_i32 s38, 8192
  buffer_load_dwordx4 v10, s[4:7], s38 offen lds
  s_add_u32 m0, s26, 33792
  s_movk_i32 s38, 8192
  buffer_load_dwordx4 v11, s[4:7], s38 offen lds
  s_add_u32 m0, s26, 65536
  s_movk_i32 s38, 16384
  buffer_load_dwordx4 v10, s[4:7], s38 offen lds
  s_add_u32 m0, s26, 66560
  s_movk_i32 s38, 16384
  buffer_load_dwordx4 v11, s[4:7], s38 offen lds
  s_lshl_b32 s38, s22, 13
  s_lshl_b32 s39, s21, 10
  s_add_u32 s38, s38, s39
  v_add_u32 v17, s38, v4
  v_and_b32 v5, 15, v1
  v_lshrrev_b32 v6, 2, v5
  v_lshlrev_b32 v7, 2, v3
  v_add_u32 v6, v6, v7
  s_lshl_b32 s38, s22, 6
  v_add_u32 v6, s38, v6
  v_lshlrev_b32 v6, 7, v6
  v_lshrrev_b32 v7, 4, v1
  v_and_b32 v7, 1, v7
  v_xor_b32 v7, s22, v7
  v_lshlrev_b32 v7, 1, v7
  v_bfe_u32 v9, v5, 1, 1
  v_add_u32 v7, v7, v9
  s_lshl_b32 s38, s25, 2
  v_add_u32 v7, s38, v7
  v_lshrrev_b32 v9, 3, v5
  v_lshlrev_b32 v9, 2, v9
  v_xor_b32 v7, v7, v9
  v_lshlrev_b32 v7, 4, v7
  v_add_u32 v6, v6, v7
  v_and_b32 v7, 1, v5
  v_lshlrev_b32 v7, 3, v7
  v_add_u32 v6, v6, v7
  v_add_u32 v21, 16384, v6
  v_add_u32 v18, 0x10000, v17
  v_add_u32 v22, 0x10000, v21
  v_add_u32 v19, 0x20000, v17
  v_add_u32 v23, 0x20000, v21
  v_mov_b32 v48, 0
  v_mov_b32 v49, 0
  v_mov_b32 v50, 0
  v_mov_b32 v51, 0
  v_mov_b32 v52, 0
  v_mov_b32 v53, 0
  v_mov_b32 v54, 0
  v_mov_b32 v55, 0
  v_mov_b32 v56, 0
  v_mov_b32 v57, 0
  v_mov_b32 v58, 0
  v_mov_b32 v59, 0
  v_mov_b32 v60, 0
  v_mov_b32 v61, 0
  v_mov_b32 v62, 0
  v_mov_b32 v63, 0
  s_waitcnt vmcnt(4)
  s_barrier
  ds_read_b128 v[32:35], v17 offset:0
  ds_read_b64_tr_b16 v[40:41], v21 offset:0
  ds_read_b64_tr_b16 v[42:43], v21 offset:1024
  ds_read_b128 v[36:39], v17 offset:2048
  ds_read_b64_tr_b16 v[44:45], v21 offset:2048
  ds_read_b64_tr_b16 v[46:47], v21 offset:3072
  s_waitcnt lgkmcnt(3)
  v_mfma_f32_32x32x16_bf16 v[48:63], v[40:43], v[32:35], v[48:63]
  s_add_u32 m0, s26, 98304
  s_movk_i32 s38, 24576
  buffer_load_dwordx4 v10, s[4:7], s38 offen lds
  s_add_u32 m0, s26, 99328
  s_movk_i32 s38, 24576
  buffer_load_dwordx4 v11, s[4:7], s38 offen lds
  ds_read_b128 v[32:35], v17 offset:4096
  ds_read_b64_tr_b16 v[40:41], v21 offset:4096
  ds_read_b64_tr_b16 v[42:43], v21 offset:5120
  s_waitcnt lgkmcnt(3)
  v_mfma_f32_32x32x16_bf16 v[48:63], v[44:47], v[36:39], v[48:63]
  s_add_u32 m0, s26, 114688
  s_mov_b32 s38, 393216
  buffer_load_dwordx4 v12, s[8:11], s38 offen lds
  s_add_u32 m0, s26, 115712
  s_mov_b32 s38, 401408
  buffer_load_dwordx4 v12, s[8:11], s38 offen lds
  ds_read_b128 v[36:39], v17 offset:6144
  ds_read_b64_tr_b16 v[44:45], v21 offset:6144
  ds_read_b64_tr_b16 v[46:47], v21 offset:7168
  s_waitcnt lgkmcnt(3)
  v_mfma_f32_32x32x16_bf16 v[48:63], v[40:43], v[32:35], v[48:63]
  s_add_u32 m0, s26, 131072
  s_mov_b32 s38, 32768
  buffer_load_dwordx4 v10, s[4:7], s38 offen lds
  s_add_u32 m0, s26, 132096
  s_mov_b32 s38, 32768
  buffer_load_dwordx4 v11, s[4:7], s38 offen lds
  s_waitcnt lgkmcnt(0)
  v_mfma_f32_32x32x16_bf16 v[48:63], v[44:47], v[36:39], v[48:63]
  s_add_u32 m0, s26, 147456
  s_mov_b32 s38, 524288
  buffer_load_dwordx4 v12, s[8:11], s38 offen lds
  s_add_u32 m0, s26, 148480
  s_mov_b32 s38, 532480
  buffer_load_dwordx4 v12, s[8:11], s38 offen lds
  s_waitcnt vmcnt(10)
  s_barrier
  ds_read_b128 v[32:35], v17 offset:32768
  ds_read_b64_tr_b16 v[40:41], v21 offset:32768
  ds_read_b64_tr_b16 v[42:43], v21 offset:33792
  ds_read_b128 v[36:39], v17 offset:34816
  ds_read_b64_tr_b16 v[44:45], v21 offset:34816
  ds_read_b64_tr_b16 v[46:47], v21 offset:35840
  s_waitcnt lgkmcnt(3)
  v_mfma_f32_32x32x16_bf16 v[48:63], v[40:43], v[32:35], v[48:63]
  s_add_u32 m0, s26, 0
  s_mov_b32 s38, 40960
  buffer_load_dwordx4 v10, s[4:7], s38 offen lds
  ds_read_b128 v[32:35], v17 offset:36864
  ds_read_b64_tr_b16 v[40:41], v21 offset:36864
  ds_read_b64_tr_b16 v[42:43], v21 offset:37888
  s_waitcnt lgkmcnt(3)
  v_mfma_f32_32x32x16_bf16 v[48:63], v[44:47], v[36:39], v[48:63]
  s_add_u32 m0, s26, 1024
  s_mov_b32 s38, 40960
  buffer_load_dwordx4 v11, s[4:7], s38 offen lds
  ds_read_b128 v[36:39], v17 offset:38912
  ds_read_b64_tr_b16 v[44:45], v21 offset:38912
  ds_read_b64_tr_b16 v[46:47], v21 offset:39936
  s_waitcnt lgkmcnt(3)
  v_mfma_f32_32x32x16_bf16 v[48:63], v[40:43], v[32:35], v[48:63]
  s_add_u32 m0, s26, 16384
  s_mov_b32 s38, 655360
  buffer_load_dwordx4 v12, s[8:11], s38 offen lds
  s_waitcnt lgkmcnt(0)
  v_mfma_f32_32x32x16_bf16 v[48:63], v[44:47], v[36:39], v[48:63]
  s_add_u32 m0, s26, 17408
  s_mov_b32 s38, 663552
  buffer_load_dwordx4 v12, s[8:11], s38 offen lds
  s_waitcnt vmcnt(12)
  s_barrier
  ds_read_b128 v[32:35], v18 offset:0
  ds_read_b64_tr_b16 v[40:41], v22 offset:0
  ds_read_b64_tr_b16 v[42:43], v22 offset:1024
  ds_read_b128 v[36:39], v18 offset:2048
  ds_read_b64_tr_b16 v[44:45], v22 offset:2048
  ds_read_b64_tr_b16 v[46:47], v22 offset:3072
  s_waitcnt lgkmcnt(3)
  v_mfma_f32_32x32x16_bf16 v[48:63], v[40:43], v[32:35], v[48:63]
  s_add_u32 m0, s26, 32768
  s_mov_b32 s38, 49152
  buffer_load_dwordx4 v10, s[4:7], s38 offen lds
  ds_read_b128 v[32:35], v18 offset:4096
  ds_read_b64_tr_b16 v[40:41], v22 offset:4096
  ds_read_b64_tr_b16 v[42:43], v22 offset:5120
  s_waitcnt lgkmcnt(3)
  v_mfma_f32_32x32x16_bf16 v[48:63], v[44:47], v[36:39], v[48:63]
  s_add_u32 m0, s26, 33792
  s_mov_b32 s38, 49152
  buffer_load_dwordx4 v11, s[4:7], s38 offen lds
  ds_read_b128 v[36:39], v18 offset:6144
  ds_read_b64_tr_b16 v[44:45], v22 offset:6144
  ds_read_b64_tr_b16 v[46:47], v22 offset:7168
  s_waitcnt lgkmcnt(3)
  v_mfma_f32_32x32x16_bf16 v[48:63], v[40:43], v[32:35], v[48:63]
  s_add_u32 m0, s26, 49152
  s_mov_b32 s38, 786432
  buffer_load_dwordx4 v12, s[8:11], s38 offen lds
  s_waitcnt lgkmcnt(0)
  v_mfma_f32_32x32x16_bf16 v[48:63], v[44:47], v[36:39], v[48:63]
  s_add_u32 m0, s26, 50176
  s_mov_b32 s38, 794624
  buffer_load_dwordx4 v12, s[8:11], s38 offen lds
  s_waitcnt vmcnt(12)
  s_barrier
  ds_read_b128 v[32:35], v18 offset:32768
  ds_read_b64_tr_b16 v[40:41], v22 offset:32768
  ds_read_b64_tr_b16 v[42:43], v22 offset:33792
  ds_read_b128 v[36:39], v18 offset:34816
  ds_read_b64_tr_b16 v[44:45], v22 offset:34816
  ds_read_b64_tr_b16 v[46:47], v22 offset:35840
  s_waitcnt lgkmcnt(3)
  v_mfma_f32_32x32x16_bf16 v[48:63], v[40:43], v[32:35], v[48:63]
  s_add_u32 m0, s26, 65536
  s_mov_b32 s38, 57344
  buffer_load_dwordx4 v10, s[4:7], s38 offen lds
  ds_read_b128 v[32:35], v18 offset:36864
  ds_read_b64_tr_b16 v[40:41], v22 offset:36864
  ds_read_b64_tr_b16 v[42:43], v22 offset:37888
  s_waitcnt lgkmcnt(3)
  v_mfma_f32_32x32x16_bf16 v[48:63], v[44:47], v[36:39], v[48:63]
  s_add_u32 m0, s26, 66560
  s_mov_b32 s38, 57344
  buffer_load_dwordx4 v11, s[4:7], s38 offen lds
  ds_read_b128 v[36:39], v18 offset:38912
  ds_read_b64_tr_b16 v[44:45], v22 offset:38912
  ds_read_b64_tr_b16 v[46:47], v22 offset:39936
  s_waitcnt lgkmcnt(3)
  v_mfma_f32_32x32x16_bf16 v[48:63], v[40:43], v[32:35], v[48:63]
  s_add_u32 m0, s26, 81920
  s_mov_b32 s38, 917504
  buffer_load_dwordx4 v12, s[8:11], s38 offen lds
  s_waitcnt lgkmcnt(0)
  v_mfma_f32_32x32x16_bf16 v[48:63], v[44:47], v[36:39], v[48:63]
  s_add_u32 m0, s26, 82944
  s_mov_b32 s38, 925696
  buffer_load_dwordx4 v12, s[8:11], s38 offen lds
  s_waitcnt vmcnt(12)
  s_barrier
  ds_read_b128 v[32:35], v19 offset:0
  ds_read_b64_tr_b16 v[40:41], v23 offset:0
  ds_read_b64_tr_b16 v[42:43], v23 offset:1024
  ds_read_b128 v[36:39], v19 offset:2048
  ds_read_b64_tr_b16 v[44:45], v23 offset:2048
  ds_read_b64_tr_b16 v[46:47], v23 offset:3072
  s_waitcnt lgkmcnt(3)
  v_mfma_f32_32x32x16_bf16 v[48:63], v[40:43], v[32:35], v[48:63]
  s_add_u32 m0, s26, 98304
  s_mov_b32 s38, 65536
  buffer_load_dwordx4 v10, s[4:7], s38 offen lds
  ds_read_b128 v[32:35], v19 offset:4096
  ds_read_b64_tr_b16 v[40:41], v23 offset:4096
  ds_read_b64_tr_b16 v[42:43], v23 offset:5120
  s_waitcnt lgkmcnt(3)
  v_mfma_f32_32x32x16_bf16 v[48:63], v[44:47], v[36:39], v[48:63]
  s_add_u32 m0, s26, 99328
  s_mov_b32 s38, 65536
  buffer_load_dwordx4 v11, s[4:7], s38 offen lds
  ds_read_b128 v[36:39], v19 offset:6144
  ds_read_b64_tr_b16 v[44:45], v23 offset:6144
  ds_read_b64_tr_b16 v[46:47], v23 offset:7168
  s_waitcnt lgkmcnt(3)
  v_mfma_f32_32x32x16_bf16 v[48:63], v[40:43], v[32:35], v[48:63]
  s_add_u32 m0, s26, 114688
  s_mov_b32 s38, 1048576
  buffer_load_dwordx4 v12, s[8:11], s38 offen lds
  s_waitcnt lgkmcnt(0)
  v_mfma_f32_32x32x16_bf16 v[48:63], v[44:47], v[36:39], v[48:63]
  s_add_u32 m0, s26, 115712
  s_mov_b32 s38, 1056768
  buffer_load_dwordx4 v12, s[8:11], s38 offen lds
  s_waitcnt vmcnt(12)
  s_barrier
  ds_read_b128 v[32:35], v17 offset:0
  ds_read_b64_tr_b16 v[40:41], v21 offset:0
  ds_read_b64_tr_b16 v[42:43], v21 offset:1024
  ds_read_b128 v[36:39], v17 offset:2048
  ds_read_b64_tr_b16 v[44:45], v21 offset:2048
  ds_read_b64_tr_b16 v[46:47], v21 offset:3072
  s_waitcnt lgkmcnt(3)
  v_mfma_f32_32x32x16_bf16 v[48:63], v[40:43], v[32:35], v[48:63]
  s_add_u32 m0, s26, 131072
  s_mov_b32 s38, 73728
  buffer_load_dwordx4 v10, s[4:7], s38 offen lds
  ds_read_b128 v[32:35], v17 offset:4096
  ds_read_b64_tr_b16 v[40:41], v21 offset:4096
  ds_read_b64_tr_b16 v[42:43], v21 offset:5120
  s_waitcnt lgkmcnt(3)
  v_mfma_f32_32x32x16_bf16 v[48:63], v[44:47], v[36:39], v[48:63]
  s_add_u32 m0, s26, 132096
  s_mov_b32 s38, 73728
  buffer_load_dwordx4 v11, s[4:7], s38 offen lds
  ds_read_b128 v[36:39], v17 offset:6144
  ds_read_b64_tr_b16 v[44:45], v21 offset:6144
  ds_read_b64_tr_b16 v[46:47], v21 offset:7168
  s_waitcnt lgkmcnt(3)
  v_mfma_f32_32x32x16_bf16 v[48:63], v[40:43], v[32:35], v[48:63]
  s_add_u32 m0, s26, 147456
  s_mov_b32 s38, 1179648
  buffer_load_dwordx4 v12, s[8:11], s38 offen lds
  s_waitcnt lgkmcnt(0)
  v_mfma_f32_32x32x16_bf16 v[48:63], v[44:47], v[36:39], v[48:63]
  s_add_u32 m0, s26, 148480
  s_mov_b32 s38, 1187840
  buffer_load_dwordx4 v12, s[8:11], s38 offen lds
  s_waitcnt vmcnt(12)
  s_barrier
  ds_read_b128 v[32:35], v17 offset:32768
  ds_read_b64_tr_b16 v[40:41], v21 offset:32768
  ds_read_b64_tr_b16 v[42:43], v21 offset:33792
  ds_read_b128 v[36:39], v17 offset:34816
  ds_read_b64_tr_b16 v[44:45], v21 offset:34816
  ds_read_b64_tr_b16 v[46:47], v21 offset:35840
  s_waitcnt lgkmcnt(3)
  v_mfma_f32_32x32x16_bf16 v[48:63], v[40:43], v[32:35], v[48:63]
  s_add_u32 m0, s26, 0
  s_mov_b32 s38, 81920
  buffer_load_dwordx4 v10, s[4:7], s38 offen lds
  ds_read_b128 v[32:35], v17 offset:36864
  ds_read_b64_tr_b16 v[40:41], v21 offset:36864
  ds_read_b64_tr_b16 v[42:43], v21 offset:37888
  s_waitcnt lgkmcnt(3)
  v_mfma_f32_32x32x16_bf16 v[48:63], v[44:47], v[36:39], v[48:63]
  s_add_u32 m0, s26, 1024
  s_mov_b32 s38, 81920
  buffer_load_dwordx4 v11, s[4:7], s38 offen lds
  ds_read_b128 v[36:39], v17 offset:38912
  ds_read_b64_tr_b16 v[44:45], v21 offset:38912
  ds_read_b64_tr_b16 v[46:47], v21 offset:39936
  s_waitcnt lgkmcnt(3)
  v_mfma_f32_32x32x16_bf16 v[48:63], v[40:43], v[32:35], v[48:63]
  s_add_u32 m0, s26, 16384
  s_mov_b32 s38, 1310720
  buffer_load_dwordx4 v12, s[8:11], s38 offen lds
  s_waitcnt lgkmcnt(0)
  v_mfma_f32_32x32x16_bf16 v[48:63], v[44:47], v[36:39], v[48:63]
  s_add_u32 m0, s26, 17408
  s_mov_b32 s38, 1318912
  buffer_load_dwordx4 v12, s[8:11], s38 offen lds
  s_waitcnt vmcnt(12)
  s_barrier
  ds_read_b128 v[32:35], v18 offset:0
  ds_read_b64_tr_b16 v[40:41], v22 offset:0
  ds_read_b64_tr_b16 v[42:43], v22 offset:1024
  ds_read_b128 v[36:39], v18 offset:2048
  ds_read_b64_tr_b16 v[44:45], v22 offset:2048
  ds_read_b64_tr_b16 v[46:47], v22 offset:3072
  s_waitcnt lgkmcnt(3)
  v_mfma_f32_32x32x16_bf16 v[48:63], v[40:43], v[32:35], v[48:63]
  ds_read_b128 v[32:35], v18 offset:4096
  ds_read_b64_tr_b16 v[40:41], v22 offset:4096
  ds_read_b64_tr_b16 v[42:43], v22 offset:5120
  s_waitcnt lgkmcnt(3)
  v_mfma_f32_32x32x16_bf16 v[48:63], v[44:47], v[36:39], v[48:63]
  ds_read_b128 v[36:39], v18 offset:6144
  ds_read_b64_tr_b16 v[44:45], v22 offset:6144
  ds_read_b64_tr_b16 v[46:47], v22 offset:7168
  s_waitcnt lgkmcnt(3)
  v_mfma_f32_32x32x16_bf16 v[48:63], v[40:43], v[32:35], v[48:63]
  s_waitcnt lgkmcnt(0)
  v_mfma_f32_32x32x16_bf16 v[48:63], v[44:47], v[36:39], v[48:63]
  s_waitcnt vmcnt(8)
  s_barrier
  ds_read_b128 v[32:35], v18 offset:32768
  ds_read_b64_tr_b16 v[40:41], v22 offset:32768
  ds_read_b64_tr_b16 v[42:43], v22 offset:33792
  ds_read_b128 v[36:39], v18 offset:34816
  ds_read_b64_tr_b16 v[44:45], v22 offset:34816
  ds_read_b64_tr_b16 v[46:47], v22 offset:35840
  s_waitcnt lgkmcnt(3)
  v_mfma_f32_32x32x16_bf16 v[48:63], v[40:43], v[32:35], v[48:63]
  ds_read_b128 v[32:35], v18 offset:36864
  ds_read_b64_tr_b16 v[40:41], v22 offset:36864
  ds_read_b64_tr_b16 v[42:43], v22 offset:37888
  s_waitcnt lgkmcnt(3)
  v_mfma_f32_32x32x16_bf16 v[48:63], v[44:47], v[36:39], v[48:63]
  ds_read_b128 v[36:39], v18 offset:38912
  ds_read_b64_tr_b16 v[44:45], v22 offset:38912
  ds_read_b64_tr_b16 v[46:47], v22 offset:39936
  s_waitcnt lgkmcnt(3)
  v_mfma_f32_32x32x16_bf16 v[48:63], v[40:43], v[32:35], v[48:63]
  s_waitcnt lgkmcnt(0)
  v_mfma_f32_32x32x16_bf16 v[48:63], v[44:47], v[36:39], v[48:63]
  s_waitcnt vmcnt(4)
  s_barrier
  ds_read_b128 v[32:35], v19 offset:0
  ds_read_b64_tr_b16 v[40:41], v23 offset:0
  ds_read_b64_tr_b16 v[42:43], v23 offset:1024
  ds_read_b128 v[36:39], v19 offset:2048
  ds_read_b64_tr_b16 v[44:45], v23 offset:2048
  ds_read_b64_tr_b16 v[46:47], v23 offset:3072
  s_waitcnt lgkmcnt(3)
  v_mfma_f32_32x32x16_bf16 v[48:63], v[40:43], v[32:35], v[48:63]
  ds_read_b128 v[32:35], v19 offset:4096
  ds_read_b64_tr_b16 v[40:41], v23 offset:4096
  ds_read_b64_tr_b16 v[42:43], v23 offset:5120
  s_waitcnt lgkmcnt(3)
  v_mfma_f32_32x32x16_bf16 v[48:63], v[44:47], v[36:39], v[48:63]
  ds_read_b128 v[36:39], v19 offset:6144
  ds_read_b64_tr_b16 v[44:45], v23 offset:6144
  ds_read_b64_tr_b16 v[46:47], v23 offset:7168
  s_waitcnt lgkmcnt(3)
  v_mfma_f32_32x32x16_bf16 v[48:63], v[40:43], v[32:35], v[48:63]
  s_waitcnt lgkmcnt(0)
  v_mfma_f32_32x32x16_bf16 v[48:63], v[44:47], v[36:39], v[48:63]
  s_waitcnt vmcnt(0)
  s_barrier
  ds_read_b128 v[32:35], v17 offset:0
  ds_read_b64_tr_b16 v[40:41], v21 offset:0
  ds_read_b64_tr_b16 v[42:43], v21 offset:1024
  ds_read_b128 v[36:39], v17 offset:2048
  ds_read_b64_tr_b16 v[44:45], v21 offset:2048
  ds_read_b64_tr_b16 v[46:47], v21 offset:3072
  s_waitcnt lgkmcnt(3)
  v_mfma_f32_32x32x16_bf16 v[48:63], v[40:43], v[32:35], v[48:63]
  ds_read_b128 v[32:35], v17 offset:4096
  ds_read_b64_tr_b16 v[40:41], v21 offset:4096
  ds_read_b64_tr_b16 v[42:43], v21 offset:5120
  s_waitcnt lgkmcnt(3)
  v_mfma_f32_32x32x16_bf16 v[48:63], v[44:47], v[36:39], v[48:63]
  s_waitcnt lgkmcnt(0)
  s_cmp_eq_u32 s22, 1
  s_cbranch_scc1 L_k5_ffn2_kernel_kdone
  ds_read_b128 v[36:39], v17 offset:6144
  ds_read_b64_tr_b16 v[44:45], v21 offset:6144
  ds_read_b64_tr_b16 v[46:47], v21 offset:7168
  s_waitcnt lgkmcnt(3)
  v_mfma_f32_32x32x16_bf16 v[48:63], v[40:43], v[32:35], v[48:63]
  s_waitcnt lgkmcnt(0)
  v_mfma_f32_32x32x16_bf16 v[48:63], v[44:47], v[36:39], v[48:63]
L_k5_ffn2_kernel_kdone:
  s_barrier
  s_lshl_b32 s38, s20, 11
  v_add_u32 v5, s38, v4
  s_nop 7
  s_nop 3
  ds_write_b128 v5, v[56:59] offset:0
  ds_write_b128 v5, v[60:63] offset:1024
  s_waitcnt lgkmcnt(0)
  s_barrier
  s_xor_b32 s39, s20, 4
  s_lshl_b32 s38, s39, 11
  v_add_u32 v5, s38, v4
  ds_read_b128 v[32:35], v5 offset:0
  ds_read_b128 v[36:39], v5 offset:1024
  s_waitcnt vmcnt(0) lgkmcnt(0)
  v_lshlrev_b32 v40, 16, v28
  v_add_f32 v48, v48, v32
  v_add_f32 v48, v48, v40
  v_and_b32 v41, 0xffff0000, v28
  v_add_f32 v49, v49, v33
  v_add_f32 v49, v49, v41
  v_lshlrev_b32 v42, 16, v29
  v_add_f32 v50, v50, v34
  v_add_f32 v50, v50, v42
  v_and_b32 v43, 0xffff0000, v29
  v_add_f32 v51, v51, v35
  v_add_f32 v51, v51, v43
  v_lshlrev_b32 v44, 16, v30
  v_add_f32 v52, v52, v36
  v_add_f32 v52, v52, v44
  v_and_b32 v45, 0xffff0000, v30
  v_add_f32 v53, v53, v37
  v_add_f32 v53, v53, v45
  v_lshlrev_b32 v46, 16, v31
  v_add_f32 v54, v54, v38
  v_add_f32 v54, v54, v46
  v_and_b32 v47, 0xffff0000, v31
  v_add_f32 v55, v55, v39
  v_add_f32 v55, v55, v47
  v_cvt_pk_bf16_f32 v32, v48, v49
  v_cvt_pk_bf16_f32 v33, v50, v51
  v_cvt_pk_bf16_f32 v34, v52, v53
  v_cvt_pk_bf16_f32 v35, v54, v55
  v_lshlrev_b32 v9, 4, v3
  v_add_u32 v9, v9, v8
  v_permlane32_swap_b32 v32, v34
  v_permlane32_swap_b32 v33, v35
  s_nop 1
  buffer_store_dwordx4 v[32:35], v9, s[12:15], s43 offen sc1
  s_waitcnt vmcnt(0)
L_k5_ffn2_kernel_end:
L_kall_kernel_end:
  s_endpgm

.section .rodata,"a"
.p2align 6
.amdhsa_kernel kall_kernel
  .amdhsa_next_free_vgpr 128
  .amdhsa_next_free_sgpr 64
  .amdhsa_accum_offset 128
  .amdhsa_group_segment_fixed_size 0
  .amdhsa_kernarg_size 80
  .amdhsa_user_sgpr_count 2
  .amdhsa_user_sgpr_kernarg_segment_ptr 1
  .amdhsa_system_sgpr_workgroup_id_x 1
.end_amdhsa_kernel
```
